```python
import torch

def _softmax(x, axis=-1):
    return torch.softmax(x, dim=axis)

def _gelu(x):
    return torch.nn.functional.gelu(x, approximate='tanh')

def _silu(x):
    return torch.nn.functional.silu(x)

def _sigmoid(x):
    return torch.sigmoid(x)

def _layernorm(x, axis=-1, eps=1e-05):
    m = x.mean(dim=axis, keepdim=True)
    v = x.var(dim=axis, keepdim=True, unbiased=False)
    return (x - m) / torch.sqrt(v + eps)

def _scatter_add(tgt, idx, src, axis=0):
    return tgt.clone().index_add_(axis, idx, src)

def _segment_sum(src, seg, n):
    out = torch.zeros((n,) + src.shape[1:], dtype=src.dtype)
    return out.index_add_(0, seg, src)

def _pad(x, pw):
    flat = tuple((v for pair in reversed(pw) for v in pair))
    return torch.nn.functional.pad(x, flat)
kernel_name = 'standalone__autoregressive_conv_wavernn__speech'

def setup_inputs():

    _w = lambda a: (lambda t: t.to(torch.bfloat16) if t.is_floating_point() else t)(torch.as_tensor(a))
    B, T, D, K = (2, 1000, 512, 5)
    return {'x': _w((lambda *s: torch.randn(*s, dtype=torch.bfloat16) * 0.05)(B, T, D)), 'w': _w((lambda *s: torch.randn(*s, dtype=torch.bfloat16) * 0.05)(K, D, 2 * D))}

def reference(x, w):
    B, T, D = x.shape
    K = w.shape[0]
    dil = 2
    pad = (K - 1) * dil
    xp = _pad(x, ((0, 0), (pad, 0), (0, 0)))
    h = torch.einsum('btd,de->bte', xp[:, 0:T, :], w[0])
    for i in range(1, K):
        h = h + torch.einsum('btd,de->bte', xp[:, i * dil:i * dil + T, :], w[i])
    f, g = (h[..., :D].clone(), h[..., D:].clone())
    return torch.tanh(f) * _sigmoid(g)
```

```asm
; @launch grid=(256,1,1) block=(256,1,1) lds=155648
.amdgcn_target "amdgcn-amd-amdhsa--gfx950"
.text
.globl standalone__autoregressive_conv_wavernn__speech_kernel
.p2align 8
.type standalone__autoregressive_conv_wavernn__speech_kernel,@function
standalone__autoregressive_conv_wavernn__speech_kernel:
    s_cmp_ge_u32 s2, 256
    s_cbranch_scc1 L_done
    s_load_dwordx2 s[4:5], s[0:1], 0
    s_load_dwordx2 s[6:7], s[0:1], 8
    s_load_dwordx2 s[8:9], s[0:1], 16
    s_and_b32 s32, s2, 7
    s_lshr_b32 s33, s2, 3
    s_and_b32 s34, s32, 1
    s_lshr_b32 s35, s32, 1
    s_and_b32 s36, s33, 7
    s_lshr_b32 s37, s33, 3
    s_lshl_b32 s35, s35, 2
    s_add_u32 s35, s35, s37
    s_lshl_b32 s28, s36, 7
    s_lshl_b32 s29, s35, 5
    v_lshrrev_b32 v1, 6, v0
    s_nop 0
    v_readfirstlane_b32 s24, v1
    v_and_b32 v2, 63, v0
    s_nop 3
    s_mul_i32 s25, s24, 20480
    s_add_u32 s25, s25, 73728
    s_mul_i32 s26, s24, 36
    s_add_u32 s26, s26, s28
    s_sub_u32 s26, s26, 8
    s_lshl_b32 s26, s26, 10
    s_lshl_b32 s27, s24, 16
    s_lshl_b32 s30, s29, 1
    s_add_u32 s27, s27, s30
    v_and_b32 v3, 31, v2
    v_lshrrev_b32 v4, 5, v2
    s_lshl_b32 s30, s24, 2
    v_add_u32 v9, s30, v4
    v_add_u32 v5, 0, v3
    v_and_b32 v6, 15, v5
    v_lshlrev_b32 v7, 8, v5
    v_add_u32 v8, 0, v9
    v_xor_b32 v8, v8, v6
    v_lshl_add_u32 v10, v8, 4, v7
    v_add_u32 v8, 2, v9
    v_xor_b32 v8, v8, v6
    v_lshl_add_u32 v11, v8, 4, v7
    v_add_u32 v5, 2, v3
    v_and_b32 v6, 15, v5
    v_lshlrev_b32 v7, 8, v5
    v_add_u32 v8, 0, v9
    v_xor_b32 v8, v8, v6
    v_lshl_add_u32 v12, v8, 4, v7
    v_add_u32 v8, 2, v9
    v_xor_b32 v8, v8, v6
    v_lshl_add_u32 v13, v8, 4, v7
    v_add_u32 v5, 4, v3
    v_and_b32 v6, 15, v5
    v_lshlrev_b32 v7, 8, v5
    v_add_u32 v8, 0, v9
    v_xor_b32 v8, v8, v6
    v_lshl_add_u32 v14, v8, 4, v7
    v_add_u32 v8, 2, v9
    v_xor_b32 v8, v8, v6
    v_lshl_add_u32 v15, v8, 4, v7
    v_add_u32 v5, 6, v3
    v_and_b32 v6, 15, v5
    v_lshlrev_b32 v7, 8, v5
    v_add_u32 v8, 0, v9
    v_xor_b32 v8, v8, v6
    v_lshl_add_u32 v16, v8, 4, v7
    v_add_u32 v8, 2, v9
    v_xor_b32 v8, v8, v6
    v_lshl_add_u32 v17, v8, 4, v7
    v_add_u32 v5, 8, v3
    v_and_b32 v6, 15, v5
    v_lshlrev_b32 v7, 8, v5
    v_add_u32 v8, 0, v9
    v_xor_b32 v8, v8, v6
    v_lshl_add_u32 v18, v8, 4, v7
    v_add_u32 v8, 2, v9
    v_xor_b32 v8, v8, v6
    v_lshl_add_u32 v19, v8, 4, v7
    v_bfe_u32 v5, v2, 2, 2
    v_lshl_add_u32 v5, v4, 3, v5
    v_lshlrev_b32 v5, 6, v5
    v_bfe_u32 v6, v2, 4, 1
    v_lshlrev_b32 v6, 5, v6
    v_and_b32 v7, 3, v2
    v_lshl_add_u32 v6, v7, 3, v6
    v_add_u32 v5, v5, v6
    v_add_u32 v20, s25, v5
    v_and_b32 v5, 15, v2
    v_lshrrev_b32 v6, 4, v2
    v_lshlrev_b32 v7, 10, v6
    s_add_u32 s30, s24, 0
    s_and_b32 s30, s30, 3
    s_lshl_b32 s30, s30, 2
    v_add_u32 v8, s30, v6
    v_xor_b32 v8, v8, v5
    v_lshl_add_u32 v22, v8, 4, v7
    s_add_u32 s30, s24, 1
    s_and_b32 s30, s30, 3
    s_lshl_b32 s30, s30, 2
    v_add_u32 v8, s30, v6
    v_xor_b32 v8, v8, v5
    v_lshl_add_u32 v23, v8, 4, v7
    s_add_u32 s30, s24, 2
    s_and_b32 s30, s30, 3
    s_lshl_b32 s30, s30, 2
    v_add_u32 v8, s30, v6
    v_xor_b32 v8, v8, v5
    v_lshl_add_u32 v24, v8, 4, v7
    s_add_u32 s30, s24, 3
    s_and_b32 s30, s30, 3
    s_lshl_b32 s30, s30, 2
    v_add_u32 v8, s30, v6
    v_xor_b32 v8, v8, v5
    v_lshl_add_u32 v25, v8, 4, v7
    v_lshrrev_b32 v5, 2, v2
    v_lshlrev_b32 v5, 11, v5
    v_and_b32 v6, 3, v2
    v_lshl_add_u32 v21, v6, 4, v5
    s_waitcnt lgkmcnt(0)
    s_mul_i32 s33, s34, 1024000
    s_add_u32 s12, s4, s33
    s_addc_u32 s13, s5, 0
    s_mov_b32 s14, 1024000
    s_mov_b32 s15, 0x00020000
    s_mov_b32 s16, s6
    s_mov_b32 s17, s7
    s_mov_b32 s18, 5242880
    s_mov_b32 s19, 0x00020000
    s_add_u32 s20, s8, s33
    s_addc_u32 s21, s9, 0
    s_mov_b32 s22, 1024000
    s_mov_b32 s23, 0x00020000
    s_add_u32 s38, s36, s37
    s_lshr_b32 s39, s36, 2
    s_and_b32 s39, s39, 1
    s_add_u32 s30, s38, 0
    s_and_b32 s30, s30, 3
    s_lshl_b32 s40, s30, 8
    s_lshl_b32 s30, s30, 18
    s_add_u32 s30, s27, s30
    s_xor_b32 s31, s39, 0
    s_lshl_b32 s31, s31, 15
    s_add_u32 s44, s30, s31
    s_xor_b32 s31, s39, 1
    s_lshl_b32 s31, s31, 15
    s_add_u32 s45, s30, s31
    s_add_u32 s30, s38, 1
    s_and_b32 s30, s30, 3
    s_lshl_b32 s41, s30, 8
    s_lshl_b32 s30, s30, 18
    s_add_u32 s30, s27, s30
    s_xor_b32 s31, s39, 0
    s_lshl_b32 s31, s31, 15
    s_add_u32 s46, s30, s31
    s_xor_b32 s31, s39, 1
    s_lshl_b32 s31, s31, 15
    s_add_u32 s47, s30, s31
    s_add_u32 s30, s38, 2
    s_and_b32 s30, s30, 3
    s_lshl_b32 s42, s30, 8
    s_lshl_b32 s30, s30, 18
    s_add_u32 s30, s27, s30
    s_xor_b32 s31, s39, 0
    s_lshl_b32 s31, s31, 15
    s_add_u32 s48, s30, s31
    s_xor_b32 s31, s39, 1
    s_lshl_b32 s31, s31, 15
    s_add_u32 s49, s30, s31
    s_add_u32 s30, s38, 3
    s_and_b32 s30, s30, 3
    s_lshl_b32 s43, s30, 8
    s_lshl_b32 s30, s30, 18
    s_add_u32 s30, s27, s30
    s_xor_b32 s31, s39, 0
    s_lshl_b32 s31, s31, 15
    s_add_u32 s50, s30, s31
    s_xor_b32 s31, s39, 1
    s_lshl_b32 s31, s31, 15
    s_add_u32 s51, s30, s31
    s_lshl_b32 s30, s39, 5
    v_xor_b32 v10, s30, v10
    v_xor_b32 v11, s30, v11
    v_xor_b32 v12, s30, v12
    v_xor_b32 v13, s30, v13
    v_xor_b32 v14, s30, v14
    v_xor_b32 v15, s30, v15
    v_xor_b32 v16, s30, v16
    v_xor_b32 v17, s30, v17
    v_xor_b32 v18, s30, v18
    v_xor_b32 v19, s30, v19
    s_mul_i32 s31, s24, 9216
    s_add_u32 m0, s31, 0
    s_add_u32 s30, s26, 0
    v_add_u32 v26, s30, v22
    buffer_load_dwordx4 v26, s[12:15], s40 offen lds
    s_add_u32 m0, s31, 1024
    s_add_u32 s30, s26, 4096
    v_add_u32 v26, s30, v23
    buffer_load_dwordx4 v26, s[12:15], s40 offen lds
    s_add_u32 m0, s31, 2048
    s_add_u32 s30, s26, 8192
    v_add_u32 v26, s30, v24
    buffer_load_dwordx4 v26, s[12:15], s40 offen lds
    s_add_u32 m0, s31, 3072
    s_add_u32 s30, s26, 12288
    v_add_u32 v26, s30, v25
    buffer_load_dwordx4 v26, s[12:15], s40 offen lds
    s_add_u32 m0, s31, 4096
    s_add_u32 s30, s26, 16384
    v_add_u32 v26, s30, v22
    buffer_load_dwordx4 v26, s[12:15], s40 offen lds
    s_add_u32 m0, s31, 5120
    s_add_u32 s30, s26, 20480
    v_add_u32 v26, s30, v23
    buffer_load_dwordx4 v26, s[12:15], s40 offen lds
    s_add_u32 m0, s31, 6144
    s_add_u32 s30, s26, 24576
    v_add_u32 v26, s30, v24
    buffer_load_dwordx4 v26, s[12:15], s40 offen lds
    s_add_u32 m0, s31, 7168
    s_add_u32 s30, s26, 28672
    v_add_u32 v26, s30, v25
    buffer_load_dwordx4 v26, s[12:15], s40 offen lds
    s_add_u32 m0, s31, 8192
    s_add_u32 s30, s26, 32768
    v_add_u32 v26, s30, v22
    buffer_load_dwordx4 v26, s[12:15], s40 offen lds
    s_add_u32 m0, s25, 0
    s_add_u32 s30, s44, 0
    buffer_load_dwordx4 v21, s[16:19], s30 offen lds
    buffer_load_dwordx4 v21, s[16:19], s30 offen offset:1024 lds
    s_add_u32 m0, s25, 2048
    s_add_u32 s30, s44, 1048576
    buffer_load_dwordx4 v21, s[16:19], s30 offen lds
    buffer_load_dwordx4 v21, s[16:19], s30 offen offset:1024 lds
    s_add_u32 m0, s25, 4096
    s_add_u32 s30, s44, 2097152
    buffer_load_dwordx4 v21, s[16:19], s30 offen lds
    buffer_load_dwordx4 v21, s[16:19], s30 offen offset:1024 lds
    s_mul_i32 s31, s24, 9216
    s_add_u32 m0, s31, 36864
    s_add_u32 s30, s26, 0
    v_add_u32 v26, s30, v22
    buffer_load_dwordx4 v26, s[12:15], s41 offen lds
    s_add_u32 m0, s31, 37888
    s_add_u32 s30, s26, 4096
    v_add_u32 v26, s30, v23
    buffer_load_dwordx4 v26, s[12:15], s41 offen lds
    s_add_u32 m0, s31, 38912
    s_add_u32 s30, s26, 8192
    v_add_u32 v26, s30, v24
    buffer_load_dwordx4 v26, s[12:15], s41 offen lds
    s_add_u32 m0, s31, 39936
    s_add_u32 s30, s26, 12288
    v_add_u32 v26, s30, v25
    buffer_load_dwordx4 v26, s[12:15], s41 offen lds
    s_add_u32 m0, s31, 40960
    s_add_u32 s30, s26, 16384
    v_add_u32 v26, s30, v22
    buffer_load_dwordx4 v26, s[12:15], s41 offen lds
    s_add_u32 m0, s31, 41984
    s_add_u32 s30, s26, 20480
    v_add_u32 v26, s30, v23
    buffer_load_dwordx4 v26, s[12:15], s41 offen lds
    s_add_u32 m0, s31, 43008
    s_add_u32 s30, s26, 24576
    v_add_u32 v26, s30, v24
    buffer_load_dwordx4 v26, s[12:15], s41 offen lds
    s_add_u32 m0, s31, 44032
    s_add_u32 s30, s26, 28672
    v_add_u32 v26, s30, v25
    buffer_load_dwordx4 v26, s[12:15], s41 offen lds
    s_add_u32 m0, s31, 45056
    s_add_u32 s30, s26, 32768
    v_add_u32 v26, s30, v22
    buffer_load_dwordx4 v26, s[12:15], s41 offen lds
    s_waitcnt vmcnt(13)
    s_barrier
    ds_read_b64_tr_b16 v[60:61], v20 offset:0
    ds_read_b64_tr_b16 v[62:63], v20 offset:256
    ds_read_b64_tr_b16 v[64:65], v20 offset:1024
    ds_read_b64_tr_b16 v[66:67], v20 offset:1280
    ds_read_b128 v[28:31], v10 offset:0
    ds_read_b128 v[32:35], v10 offset:8192
    ds_read_b128 v[36:39], v10 offset:16384
    ds_read_b128 v[40:43], v10 offset:24576
    s_waitcnt lgkmcnt(0)
    s_add_u32 m0, s25, 6144
    s_add_u32 s30, s44, 3145728
    buffer_load_dwordx4 v21, s[16:19], s30 offen lds
    buffer_load_dwordx4 v21, s[16:19], s30 offen offset:1024 lds
    s_waitcnt vmcnt(13)
    ds_read_b64_tr_b16 v[68:69], v20 offset:2048
    v_mfma_f32_32x32x16_bf16 a[0:15], v[28:31], v[60:63], 0
    ds_read_b64_tr_b16 v[70:71], v20 offset:2304
    v_mfma_f32_32x32x16_bf16 a[16:31], v[28:31], v[64:67], 0
    ds_read_b64_tr_b16 v[72:73], v20 offset:3072
    v_mfma_f32_32x32x16_bf16 a[32:47], v[32:35], v[60:63], 0
    ds_read_b64_tr_b16 v[74:75], v20 offset:3328
    v_mfma_f32_32x32x16_bf16 a[48:63], v[32:35], v[64:67], 0
    ds_read_b128 v[44:47], v12 offset:0
    v_mfma_f32_32x32x16_bf16 a[64:79], v[36:39], v[60:63], 0
    ds_read_b128 v[48:51], v12 offset:8192
    v_mfma_f32_32x32x16_bf16 a[80:95], v[36:39], v[64:67], 0
    ds_read_b128 v[52:55], v12 offset:16384
    v_mfma_f32_32x32x16_bf16 a[96:111], v[40:43], v[60:63], 0
    ds_read_b128 v[56:59], v12 offset:24576
    v_mfma_f32_32x32x16_bf16 a[112:127], v[40:43], v[64:67], 0
    s_waitcnt lgkmcnt(0)
    s_add_u32 m0, s25, 8192
    s_add_u32 s30, s44, 4194304
    buffer_load_dwordx4 v21, s[16:19], s30 offen lds
    buffer_load_dwordx4 v21, s[16:19], s30 offen offset:1024 lds
    s_waitcnt vmcnt(13)
    ds_read_b64_tr_b16 v[60:61], v20 offset:4096
    v_mfma_f32_32x32x16_bf16 a[0:15], v[44:47], v[68:71], a[0:15]
    ds_read_b64_tr_b16 v[62:63], v20 offset:4352
    v_mfma_f32_32x32x16_bf16 a[16:31], v[44:47], v[72:75], a[16:31]
    ds_read_b64_tr_b16 v[64:65], v20 offset:5120
    v_mfma_f32_32x32x16_bf16 a[32:47], v[48:51], v[68:71], a[32:47]
    ds_read_b64_tr_b16 v[66:67], v20 offset:5376
    v_mfma_f32_32x32x16_bf16 a[48:63], v[48:51], v[72:75], a[48:63]
    ds_read_b128 v[28:31], v14 offset:0
    v_mfma_f32_32x32x16_bf16 a[64:79], v[52:55], v[68:71], a[64:79]
    ds_read_b128 v[32:35], v14 offset:8192
    v_mfma_f32_32x32x16_bf16 a[80:95], v[52:55], v[72:75], a[80:95]
    ds_read_b128 v[36:39], v14 offset:16384
    v_mfma_f32_32x32x16_bf16 a[96:111], v[56:59], v[68:71], a[96:111]
    ds_read_b128 v[40:43], v14 offset:24576
    v_mfma_f32_32x32x16_bf16 a[112:127], v[56:59], v[72:75], a[112:127]
    s_waitcnt lgkmcnt(0)
    s_add_u32 m0, s25, 10240
    s_add_u32 s30, s45, 0
    buffer_load_dwordx4 v21, s[16:19], s30 offen lds
    buffer_load_dwordx4 v21, s[16:19], s30 offen offset:1024 lds
    s_waitcnt vmcnt(4)
    ds_read_b64_tr_b16 v[68:69], v20 offset:6144
    v_mfma_f32_32x32x16_bf16 a[0:15], v[28:31], v[60:63], a[0:15]
    ds_read_b64_tr_b16 v[70:71], v20 offset:6400
    v_mfma_f32_32x32x16_bf16 a[16:31], v[28:31], v[64:67], a[16:31]
    ds_read_b64_tr_b16 v[72:73], v20 offset:7168
    v_mfma_f32_32x32x16_bf16 a[32:47], v[32:35], v[60:63], a[32:47]
    ds_read_b64_tr_b16 v[74:75], v20 offset:7424
    v_mfma_f32_32x32x16_bf16 a[48:63], v[32:35], v[64:67], a[48:63]
    ds_read_b128 v[44:47], v16 offset:0
    v_mfma_f32_32x32x16_bf16 a[64:79], v[36:39], v[60:63], a[64:79]
    ds_read_b128 v[48:51], v16 offset:8192
    v_mfma_f32_32x32x16_bf16 a[80:95], v[36:39], v[64:67], a[80:95]
    ds_read_b128 v[52:55], v16 offset:16384
    v_mfma_f32_32x32x16_bf16 a[96:111], v[40:43], v[60:63], a[96:111]
    ds_read_b128 v[56:59], v16 offset:24576
    v_mfma_f32_32x32x16_bf16 a[112:127], v[40:43], v[64:67], a[112:127]
    s_waitcnt lgkmcnt(0)
    s_add_u32 m0, s25, 12288
    s_add_u32 s30, s45, 1048576
    buffer_load_dwordx4 v21, s[16:19], s30 offen lds
    buffer_load_dwordx4 v21, s[16:19], s30 offen offset:1024 lds
    s_waitcnt vmcnt(4)
    ds_read_b64_tr_b16 v[60:61], v20 offset:8192
    v_mfma_f32_32x32x16_bf16 a[0:15], v[44:47], v[68:71], a[0:15]
    ds_read_b64_tr_b16 v[62:63], v20 offset:8448
    v_mfma_f32_32x32x16_bf16 a[16:31], v[44:47], v[72:75], a[16:31]
    ds_read_b64_tr_b16 v[64:65], v20 offset:9216
    v_mfma_f32_32x32x16_bf16 a[32:47], v[48:51], v[68:71], a[32:47]
    ds_read_b64_tr_b16 v[66:67], v20 offset:9472
    v_mfma_f32_32x32x16_bf16 a[48:63], v[48:51], v[72:75], a[48:63]
    ds_read_b128 v[28:31], v18 offset:0
    v_mfma_f32_32x32x16_bf16 a[64:79], v[52:55], v[68:71], a[64:79]
    ds_read_b128 v[32:35], v18 offset:8192
    v_mfma_f32_32x32x16_bf16 a[80:95], v[52:55], v[72:75], a[80:95]
    ds_read_b128 v[36:39], v18 offset:16384
    v_mfma_f32_32x32x16_bf16 a[96:111], v[56:59], v[68:71], a[96:111]
    ds_read_b128 v[40:43], v18 offset:24576
    v_mfma_f32_32x32x16_bf16 a[112:127], v[56:59], v[72:75], a[112:127]
    s_waitcnt lgkmcnt(0)
    s_add_u32 m0, s25, 14336
    s_add_u32 s30, s45, 2097152
    buffer_load_dwordx4 v21, s[16:19], s30 offen lds
    buffer_load_dwordx4 v21, s[16:19], s30 offen offset:1024 lds
    s_waitcnt vmcnt(4)
    ds_read_b64_tr_b16 v[68:69], v20 offset:10240
    v_mfma_f32_32x32x16_bf16 a[0:15], v[28:31], v[60:63], a[0:15]
    ds_read_b64_tr_b16 v[70:71], v20 offset:10496
    v_mfma_f32_32x32x16_bf16 a[16:31], v[28:31], v[64:67], a[16:31]
    ds_read_b64_tr_b16 v[72:73], v20 offset:11264
    v_mfma_f32_32x32x16_bf16 a[32:47], v[32:35], v[60:63], a[32:47]
    ds_read_b64_tr_b16 v[74:75], v20 offset:11520
    v_mfma_f32_32x32x16_bf16 a[48:63], v[32:35], v[64:67], a[48:63]
    ds_read_b128 v[44:47], v11 offset:0
    v_mfma_f32_32x32x16_bf16 a[64:79], v[36:39], v[60:63], a[64:79]
    ds_read_b128 v[48:51], v11 offset:8192
    v_mfma_f32_32x32x16_bf16 a[80:95], v[36:39], v[64:67], a[80:95]
    ds_read_b128 v[52:55], v11 offset:16384
    v_mfma_f32_32x32x16_bf16 a[96:111], v[40:43], v[60:63], a[96:111]
    ds_read_b128 v[56:59], v11 offset:24576
    v_mfma_f32_32x32x16_bf16 a[112:127], v[40:43], v[64:67], a[112:127]
    s_waitcnt lgkmcnt(0)
    s_add_u32 m0, s25, 16384
    s_add_u32 s30, s45, 3145728
    buffer_load_dwordx4 v21, s[16:19], s30 offen lds
    buffer_load_dwordx4 v21, s[16:19], s30 offen offset:1024 lds
    s_waitcnt vmcnt(4)
    ds_read_b64_tr_b16 v[60:61], v20 offset:12288
    v_mfma_f32_32x32x16_bf16 a[0:15], v[44:47], v[68:71], a[0:15]
    ds_read_b64_tr_b16 v[62:63], v20 offset:12544
    v_mfma_f32_32x32x16_bf16 a[16:31], v[44:47], v[72:75], a[16:31]
    ds_read_b64_tr_b16 v[64:65], v20 offset:13312
    v_mfma_f32_32x32x16_bf16 a[32:47], v[48:51], v[68:71], a[32:47]
    ds_read_b64_tr_b16 v[66:67], v20 offset:13568
    v_mfma_f32_32x32x16_bf16 a[48:63], v[48:51], v[72:75], a[48:63]
    ds_read_b128 v[28:31], v13 offset:0
    v_mfma_f32_32x32x16_bf16 a[64:79], v[52:55], v[68:71], a[64:79]
    ds_read_b128 v[32:35], v13 offset:8192
    v_mfma_f32_32x32x16_bf16 a[80:95], v[52:55], v[72:75], a[80:95]
    ds_read_b128 v[36:39], v13 offset:16384
    v_mfma_f32_32x32x16_bf16 a[96:111], v[56:59], v[68:71], a[96:111]
    ds_read_b128 v[40:43], v13 offset:24576
    v_mfma_f32_32x32x16_bf16 a[112:127], v[56:59], v[72:75], a[112:127]
    s_waitcnt lgkmcnt(0)
    s_add_u32 m0, s25, 18432
    s_add_u32 s30, s45, 4194304
    buffer_load_dwordx4 v21, s[16:19], s30 offen lds
    buffer_load_dwordx4 v21, s[16:19], s30 offen offset:1024 lds
    s_waitcnt vmcnt(4)
    ds_read_b64_tr_b16 v[68:69], v20 offset:14336
    v_mfma_f32_32x32x16_bf16 a[0:15], v[28:31], v[60:63], a[0:15]
    ds_read_b64_tr_b16 v[70:71], v20 offset:14592
    v_mfma_f32_32x32x16_bf16 a[16:31], v[28:31], v[64:67], a[16:31]
    ds_read_b64_tr_b16 v[72:73], v20 offset:15360
    v_mfma_f32_32x32x16_bf16 a[32:47], v[32:35], v[60:63], a[32:47]
    ds_read_b64_tr_b16 v[74:75], v20 offset:15616
    v_mfma_f32_32x32x16_bf16 a[48:63], v[32:35], v[64:67], a[48:63]
    ds_read_b128 v[44:47], v15 offset:0
    v_mfma_f32_32x32x16_bf16 a[64:79], v[36:39], v[60:63], a[64:79]
    ds_read_b128 v[48:51], v15 offset:8192
    v_mfma_f32_32x32x16_bf16 a[80:95], v[36:39], v[64:67], a[80:95]
    ds_read_b128 v[52:55], v15 offset:16384
    v_mfma_f32_32x32x16_bf16 a[96:111], v[40:43], v[60:63], a[96:111]
    ds_read_b128 v[56:59], v15 offset:24576
    v_mfma_f32_32x32x16_bf16 a[112:127], v[40:43], v[64:67], a[112:127]
    s_waitcnt lgkmcnt(0)
    s_add_u32 m0, s25, 0
    s_add_u32 s30, s46, 0
    buffer_load_dwordx4 v21, s[16:19], s30 offen lds
    buffer_load_dwordx4 v21, s[16:19], s30 offen offset:1024 lds
    s_waitcnt vmcnt(4)
    ds_read_b64_tr_b16 v[60:61], v20 offset:16384
    v_mfma_f32_32x32x16_bf16 a[0:15], v[44:47], v[68:71], a[0:15]
    ds_read_b64_tr_b16 v[62:63], v20 offset:16640
    v_mfma_f32_32x32x16_bf16 a[16:31], v[44:47], v[72:75], a[16:31]
    ds_read_b64_tr_b16 v[64:65], v20 offset:17408
    v_mfma_f32_32x32x16_bf16 a[32:47], v[48:51], v[68:71], a[32:47]
    ds_read_b64_tr_b16 v[66:67], v20 offset:17664
    v_mfma_f32_32x32x16_bf16 a[48:63], v[48:51], v[72:75], a[48:63]
    ds_read_b128 v[28:31], v17 offset:0
    v_mfma_f32_32x32x16_bf16 a[64:79], v[52:55], v[68:71], a[64:79]
    ds_read_b128 v[32:35], v17 offset:8192
    v_mfma_f32_32x32x16_bf16 a[80:95], v[52:55], v[72:75], a[80:95]
    ds_read_b128 v[36:39], v17 offset:16384
    v_mfma_f32_32x32x16_bf16 a[96:111], v[56:59], v[68:71], a[96:111]
    ds_read_b128 v[40:43], v17 offset:24576
    v_mfma_f32_32x32x16_bf16 a[112:127], v[56:59], v[72:75], a[112:127]
    s_waitcnt lgkmcnt(0)
    s_add_u32 m0, s25, 2048
    s_add_u32 s30, s46, 1048576
    buffer_load_dwordx4 v21, s[16:19], s30 offen lds
    buffer_load_dwordx4 v21, s[16:19], s30 offen offset:1024 lds
    s_waitcnt vmcnt(4)
    ds_read_b64_tr_b16 v[68:69], v20 offset:18432
    v_mfma_f32_32x32x16_bf16 a[0:15], v[28:31], v[60:63], a[0:15]
    ds_read_b64_tr_b16 v[70:71], v20 offset:18688
    v_mfma_f32_32x32x16_bf16 a[16:31], v[28:31], v[64:67], a[16:31]
    ds_read_b64_tr_b16 v[72:73], v20 offset:19456
    v_mfma_f32_32x32x16_bf16 a[32:47], v[32:35], v[60:63], a[32:47]
    ds_read_b64_tr_b16 v[74:75], v20 offset:19712
    v_mfma_f32_32x32x16_bf16 a[48:63], v[32:35], v[64:67], a[48:63]
    ds_read_b128 v[44:47], v19 offset:0
    v_mfma_f32_32x32x16_bf16 a[64:79], v[36:39], v[60:63], a[64:79]
    ds_read_b128 v[48:51], v19 offset:8192
    v_mfma_f32_32x32x16_bf16 a[80:95], v[36:39], v[64:67], a[80:95]
    ds_read_b128 v[52:55], v19 offset:16384
    v_mfma_f32_32x32x16_bf16 a[96:111], v[40:43], v[60:63], a[96:111]
    ds_read_b128 v[56:59], v19 offset:24576
    v_mfma_f32_32x32x16_bf16 a[112:127], v[40:43], v[64:67], a[112:127]
    s_waitcnt lgkmcnt(0)
    s_add_u32 m0, s25, 4096
    s_add_u32 s30, s46, 2097152
    buffer_load_dwordx4 v21, s[16:19], s30 offen lds
    buffer_load_dwordx4 v21, s[16:19], s30 offen offset:1024 lds
    s_waitcnt vmcnt(4)
    s_barrier
    s_mul_i32 s31, s24, 9216
    s_add_u32 m0, s31, 0
    s_add_u32 s30, s26, 0
    v_add_u32 v26, s30, v22
    buffer_load_dwordx4 v26, s[12:15], s42 offen lds
    s_add_u32 m0, s31, 1024
    s_add_u32 s30, s26, 4096
    v_add_u32 v26, s30, v23
    buffer_load_dwordx4 v26, s[12:15], s42 offen lds
    s_add_u32 m0, s31, 2048
    s_add_u32 s30, s26, 8192
    v_add_u32 v26, s30, v24
    buffer_load_dwordx4 v26, s[12:15], s42 offen lds
    s_add_u32 m0, s31, 3072
    s_add_u32 s30, s26, 12288
    v_add_u32 v26, s30, v25
    buffer_load_dwordx4 v26, s[12:15], s42 offen lds
    s_add_u32 m0, s31, 4096
    s_add_u32 s30, s26, 16384
    v_add_u32 v26, s30, v22
    buffer_load_dwordx4 v26, s[12:15], s42 offen lds
    s_add_u32 m0, s31, 5120
    s_add_u32 s30, s26, 20480
    v_add_u32 v26, s30, v23
    buffer_load_dwordx4 v26, s[12:15], s42 offen lds
    s_add_u32 m0, s31, 6144
    s_add_u32 s30, s26, 24576
    v_add_u32 v26, s30, v24
    buffer_load_dwordx4 v26, s[12:15], s42 offen lds
    s_add_u32 m0, s31, 7168
    s_add_u32 s30, s26, 28672
    v_add_u32 v26, s30, v25
    buffer_load_dwordx4 v26, s[12:15], s42 offen lds
    s_add_u32 m0, s31, 8192
    s_add_u32 s30, s26, 32768
    v_add_u32 v26, s30, v22
    buffer_load_dwordx4 v26, s[12:15], s42 offen lds
    ds_read_b64_tr_b16 v[60:61], v20 offset:0
    v_mfma_f32_32x32x16_bf16 a[0:15], v[44:47], v[68:71], a[0:15]
    ds_read_b64_tr_b16 v[62:63], v20 offset:256
    v_mfma_f32_32x32x16_bf16 a[16:31], v[44:47], v[72:75], a[16:31]
    ds_read_b64_tr_b16 v[64:65], v20 offset:1024
    v_mfma_f32_32x32x16_bf16 a[32:47], v[48:51], v[68:71], a[32:47]
    ds_read_b64_tr_b16 v[66:67], v20 offset:1280
    v_mfma_f32_32x32x16_bf16 a[48:63], v[48:51], v[72:75], a[48:63]
    ds_read_b128 v[28:31], v10 offset:36864
    v_mfma_f32_32x32x16_bf16 a[64:79], v[52:55], v[68:71], a[64:79]
    ds_read_b128 v[32:35], v10 offset:45056
    v_mfma_f32_32x32x16_bf16 a[80:95], v[52:55], v[72:75], a[80:95]
    ds_read_b128 v[36:39], v10 offset:53248
    v_mfma_f32_32x32x16_bf16 a[96:111], v[56:59], v[68:71], a[96:111]
    ds_read_b128 v[40:43], v10 offset:61440
    v_mfma_f32_32x32x16_bf16 a[112:127], v[56:59], v[72:75], a[112:127]
    s_waitcnt lgkmcnt(0)
    s_add_u32 m0, s25, 6144
    s_add_u32 s30, s46, 3145728
    buffer_load_dwordx4 v21, s[16:19], s30 offen lds
    buffer_load_dwordx4 v21, s[16:19], s30 offen offset:1024 lds
    s_waitcnt vmcnt(13)
    ds_read_b64_tr_b16 v[68:69], v20 offset:2048
    v_mfma_f32_32x32x16_bf16 a[0:15], v[28:31], v[60:63], a[0:15]
    ds_read_b64_tr_b16 v[70:71], v20 offset:2304
    v_mfma_f32_32x32x16_bf16 a[16:31], v[28:31], v[64:67], a[16:31]
    ds_read_b64_tr_b16 v[72:73], v20 offset:3072
    v_mfma_f32_32x32x16_bf16 a[32:47], v[32:35], v[60:63], a[32:47]
    ds_read_b64_tr_b16 v[74:75], v20 offset:3328
    v_mfma_f32_32x32x16_bf16 a[48:63], v[32:35], v[64:67], a[48:63]
    ds_read_b128 v[44:47], v12 offset:36864
    v_mfma_f32_32x32x16_bf16 a[64:79], v[36:39], v[60:63], a[64:79]
    ds_read_b128 v[48:51], v12 offset:45056
    v_mfma_f32_32x32x16_bf16 a[80:95], v[36:39], v[64:67], a[80:95]
    ds_read_b128 v[52:55], v12 offset:53248
    v_mfma_f32_32x32x16_bf16 a[96:111], v[40:43], v[60:63], a[96:111]
    ds_read_b128 v[56:59], v12 offset:61440
    v_mfma_f32_32x32x16_bf16 a[112:127], v[40:43], v[64:67], a[112:127]
    s_waitcnt lgkmcnt(0)
    s_add_u32 m0, s25, 8192
    s_add_u32 s30, s46, 4194304
    buffer_load_dwordx4 v21, s[16:19], s30 offen lds
    buffer_load_dwordx4 v21, s[16:19], s30 offen offset:1024 lds
    s_waitcnt vmcnt(13)
    ds_read_b64_tr_b16 v[60:61], v20 offset:4096
    v_mfma_f32_32x32x16_bf16 a[0:15], v[44:47], v[68:71], a[0:15]
    ds_read_b64_tr_b16 v[62:63], v20 offset:4352
    v_mfma_f32_32x32x16_bf16 a[16:31], v[44:47], v[72:75], a[16:31]
    ds_read_b64_tr_b16 v[64:65], v20 offset:5120
    v_mfma_f32_32x32x16_bf16 a[32:47], v[48:51], v[68:71], a[32:47]
    ds_read_b64_tr_b16 v[66:67], v20 offset:5376
    v_mfma_f32_32x32x16_bf16 a[48:63], v[48:51], v[72:75], a[48:63]
    ds_read_b128 v[28:31], v14 offset:36864
    v_mfma_f32_32x32x16_bf16 a[64:79], v[52:55], v[68:71], a[64:79]
    ds_read_b128 v[32:35], v14 offset:45056
    v_mfma_f32_32x32x16_bf16 a[80:95], v[52:55], v[72:75], a[80:95]
    ds_read_b128 v[36:39], v14 offset:53248
    v_mfma_f32_32x32x16_bf16 a[96:111], v[56:59], v[68:71], a[96:111]
    ds_read_b128 v[40:43], v14 offset:61440
    v_mfma_f32_32x32x16_bf16 a[112:127], v[56:59], v[72:75], a[112:127]
    s_waitcnt lgkmcnt(0)
    s_add_u32 m0, s25, 10240
    s_add_u32 s30, s47, 0
    buffer_load_dwordx4 v21, s[16:19], s30 offen lds
    buffer_load_dwordx4 v21, s[16:19], s30 offen offset:1024 lds
    s_waitcnt vmcnt(4)
    ds_read_b64_tr_b16 v[68:69], v20 offset:6144
    v_mfma_f32_32x32x16_bf16 a[0:15], v[28:31], v[60:63], a[0:15]
    ds_read_b64_tr_b16 v[70:71], v20 offset:6400
    v_mfma_f32_32x32x16_bf16 a[16:31], v[28:31], v[64:67], a[16:31]
    ds_read_b64_tr_b16 v[72:73], v20 offset:7168
    v_mfma_f32_32x32x16_bf16 a[32:47], v[32:35], v[60:63], a[32:47]
    ds_read_b64_tr_b16 v[74:75], v20 offset:7424
    v_mfma_f32_32x32x16_bf16 a[48:63], v[32:35], v[64:67], a[48:63]
    ds_read_b128 v[44:47], v16 offset:36864
    v_mfma_f32_32x32x16_bf16 a[64:79], v[36:39], v[60:63], a[64:79]
    ds_read_b128 v[48:51], v16 offset:45056
    v_mfma_f32_32x32x16_bf16 a[80:95], v[36:39], v[64:67], a[80:95]
    ds_read_b128 v[52:55], v16 offset:53248
    v_mfma_f32_32x32x16_bf16 a[96:111], v[40:43], v[60:63], a[96:111]
    ds_read_b128 v[56:59], v16 offset:61440
    v_mfma_f32_32x32x16_bf16 a[112:127], v[40:43], v[64:67], a[112:127]
    s_waitcnt lgkmcnt(0)
    s_add_u32 m0, s25, 12288
    s_add_u32 s30, s47, 1048576
    buffer_load_dwordx4 v21, s[16:19], s30 offen lds
    buffer_load_dwordx4 v21, s[16:19], s30 offen offset:1024 lds
    s_waitcnt vmcnt(4)
    ds_read_b64_tr_b16 v[60:61], v20 offset:8192
    v_mfma_f32_32x32x16_bf16 a[0:15], v[44:47], v[68:71], a[0:15]
    ds_read_b64_tr_b16 v[62:63], v20 offset:8448
    v_mfma_f32_32x32x16_bf16 a[16:31], v[44:47], v[72:75], a[16:31]
    ds_read_b64_tr_b16 v[64:65], v20 offset:9216
    v_mfma_f32_32x32x16_bf16 a[32:47], v[48:51], v[68:71], a[32:47]
    ds_read_b64_tr_b16 v[66:67], v20 offset:9472
    v_mfma_f32_32x32x16_bf16 a[48:63], v[48:51], v[72:75], a[48:63]
    ds_read_b128 v[28:31], v18 offset:36864
    v_mfma_f32_32x32x16_bf16 a[64:79], v[52:55], v[68:71], a[64:79]
    ds_read_b128 v[32:35], v18 offset:45056
    v_mfma_f32_32x32x16_bf16 a[80:95], v[52:55], v[72:75], a[80:95]
    ds_read_b128 v[36:39], v18 offset:53248
    v_mfma_f32_32x32x16_bf16 a[96:111], v[56:59], v[68:71], a[96:111]
    ds_read_b128 v[40:43], v18 offset:61440
    v_mfma_f32_32x32x16_bf16 a[112:127], v[56:59], v[72:75], a[112:127]
    s_waitcnt lgkmcnt(0)
    s_add_u32 m0, s25, 14336
    s_add_u32 s30, s47, 2097152
    buffer_load_dwordx4 v21, s[16:19], s30 offen lds
    buffer_load_dwordx4 v21, s[16:19], s30 offen offset:1024 lds
    s_waitcnt vmcnt(4)
    ds_read_b64_tr_b16 v[68:69], v20 offset:10240
    v_mfma_f32_32x32x16_bf16 a[0:15], v[28:31], v[60:63], a[0:15]
    ds_read_b64_tr_b16 v[70:71], v20 offset:10496
    v_mfma_f32_32x32x16_bf16 a[16:31], v[28:31], v[64:67], a[16:31]
    ds_read_b64_tr_b16 v[72:73], v20 offset:11264
    v_mfma_f32_32x32x16_bf16 a[32:47], v[32:35], v[60:63], a[32:47]
    ds_read_b64_tr_b16 v[74:75], v20 offset:11520
    v_mfma_f32_32x32x16_bf16 a[48:63], v[32:35], v[64:67], a[48:63]
    ds_read_b128 v[44:47], v11 offset:36864
    v_mfma_f32_32x32x16_bf16 a[64:79], v[36:39], v[60:63], a[64:79]
    ds_read_b128 v[48:51], v11 offset:45056
    v_mfma_f32_32x32x16_bf16 a[80:95], v[36:39], v[64:67], a[80:95]
    ds_read_b128 v[52:55], v11 offset:53248
    v_mfma_f32_32x32x16_bf16 a[96:111], v[40:43], v[60:63], a[96:111]
    ds_read_b128 v[56:59], v11 offset:61440
    v_mfma_f32_32x32x16_bf16 a[112:127], v[40:43], v[64:67], a[112:127]
    s_waitcnt lgkmcnt(0)
    s_add_u32 m0, s25, 16384
    s_add_u32 s30, s47, 3145728
    buffer_load_dwordx4 v21, s[16:19], s30 offen lds
    buffer_load_dwordx4 v21, s[16:19], s30 offen offset:1024 lds
    s_waitcnt vmcnt(4)
    ds_read_b64_tr_b16 v[60:61], v20 offset:12288
    v_mfma_f32_32x32x16_bf16 a[0:15], v[44:47], v[68:71], a[0:15]
    ds_read_b64_tr_b16 v[62:63], v20 offset:12544
    v_mfma_f32_32x32x16_bf16 a[16:31], v[44:47], v[72:75], a[16:31]
    ds_read_b64_tr_b16 v[64:65], v20 offset:13312
    v_mfma_f32_32x32x16_bf16 a[32:47], v[48:51], v[68:71], a[32:47]
    ds_read_b64_tr_b16 v[66:67], v20 offset:13568
    v_mfma_f32_32x32x16_bf16 a[48:63], v[48:51], v[72:75], a[48:63]
    ds_read_b128 v[28:31], v13 offset:36864
    v_mfma_f32_32x32x16_bf16 a[64:79], v[52:55], v[68:71], a[64:79]
    ds_read_b128 v[32:35], v13 offset:45056
    v_mfma_f32_32x32x16_bf16 a[80:95], v[52:55], v[72:75], a[80:95]
    ds_read_b128 v[36:39], v13 offset:53248
    v_mfma_f32_32x32x16_bf16 a[96:111], v[56:59], v[68:71], a[96:111]
    ds_read_b128 v[40:43], v13 offset:61440
    v_mfma_f32_32x32x16_bf16 a[112:127], v[56:59], v[72:75], a[112:127]
    s_waitcnt lgkmcnt(0)
    s_add_u32 m0, s25, 18432
    s_add_u32 s30, s47, 4194304
    buffer_load_dwordx4 v21, s[16:19], s30 offen lds
    buffer_load_dwordx4 v21, s[16:19], s30 offen offset:1024 lds
    s_waitcnt vmcnt(4)
    ds_read_b64_tr_b16 v[68:69], v20 offset:14336
    v_mfma_f32_32x32x16_bf16 a[0:15], v[28:31], v[60:63], a[0:15]
    ds_read_b64_tr_b16 v[70:71], v20 offset:14592
    v_mfma_f32_32x32x16_bf16 a[16:31], v[28:31], v[64:67], a[16:31]
    ds_read_b64_tr_b16 v[72:73], v20 offset:15360
    v_mfma_f32_32x32x16_bf16 a[32:47], v[32:35], v[60:63], a[32:47]
    ds_read_b64_tr_b16 v[74:75], v20 offset:15616
    v_mfma_f32_32x32x16_bf16 a[48:63], v[32:35], v[64:67], a[48:63]
    ds_read_b128 v[44:47], v15 offset:36864
    v_mfma_f32_32x32x16_bf16 a[64:79], v[36:39], v[60:63], a[64:79]
    ds_read_b128 v[48:51], v15 offset:45056
    v_mfma_f32_32x32x16_bf16 a[80:95], v[36:39], v[64:67], a[80:95]
    ds_read_b128 v[52:55], v15 offset:53248
    v_mfma_f32_32x32x16_bf16 a[96:111], v[40:43], v[60:63], a[96:111]
    ds_read_b128 v[56:59], v15 offset:61440
    v_mfma_f32_32x32x16_bf16 a[112:127], v[40:43], v[64:67], a[112:127]
    s_waitcnt lgkmcnt(0)
    s_add_u32 m0, s25, 0
    s_add_u32 s30, s48, 0
    buffer_load_dwordx4 v21, s[16:19], s30 offen lds
    buffer_load_dwordx4 v21, s[16:19], s30 offen offset:1024 lds
    s_waitcnt vmcnt(4)
    ds_read_b64_tr_b16 v[60:61], v20 offset:16384
    v_mfma_f32_32x32x16_bf16 a[0:15], v[44:47], v[68:71], a[0:15]
    ds_read_b64_tr_b16 v[62:63], v20 offset:16640
    v_mfma_f32_32x32x16_bf16 a[16:31], v[44:47], v[72:75], a[16:31]
    ds_read_b64_tr_b16 v[64:65], v20 offset:17408
    v_mfma_f32_32x32x16_bf16 a[32:47], v[48:51], v[68:71], a[32:47]
    ds_read_b64_tr_b16 v[66:67], v20 offset:17664
    v_mfma_f32_32x32x16_bf16 a[48:63], v[48:51], v[72:75], a[48:63]
    ds_read_b128 v[28:31], v17 offset:36864
    v_mfma_f32_32x32x16_bf16 a[64:79], v[52:55], v[68:71], a[64:79]
    ds_read_b128 v[32:35], v17 offset:45056
    v_mfma_f32_32x32x16_bf16 a[80:95], v[52:55], v[72:75], a[80:95]
    ds_read_b128 v[36:39], v17 offset:53248
    v_mfma_f32_32x32x16_bf16 a[96:111], v[56:59], v[68:71], a[96:111]
    ds_read_b128 v[40:43], v17 offset:61440
    v_mfma_f32_32x32x16_bf16 a[112:127], v[56:59], v[72:75], a[112:127]
    s_waitcnt lgkmcnt(0)
    s_add_u32 m0, s25, 2048
    s_add_u32 s30, s48, 1048576
    buffer_load_dwordx4 v21, s[16:19], s30 offen lds
    buffer_load_dwordx4 v21, s[16:19], s30 offen offset:1024 lds
    s_waitcnt vmcnt(4)
    ds_read_b64_tr_b16 v[68:69], v20 offset:18432
    v_mfma_f32_32x32x16_bf16 a[0:15], v[28:31], v[60:63], a[0:15]
    ds_read_b64_tr_b16 v[70:71], v20 offset:18688
    v_mfma_f32_32x32x16_bf16 a[16:31], v[28:31], v[64:67], a[16:31]
    ds_read_b64_tr_b16 v[72:73], v20 offset:19456
    v_mfma_f32_32x32x16_bf16 a[32:47], v[32:35], v[60:63], a[32:47]
    ds_read_b64_tr_b16 v[74:75], v20 offset:19712
    v_mfma_f32_32x32x16_bf16 a[48:63], v[32:35], v[64:67], a[48:63]
    ds_read_b128 v[44:47], v19 offset:36864
    v_mfma_f32_32x32x16_bf16 a[64:79], v[36:39], v[60:63], a[64:79]
    ds_read_b128 v[48:51], v19 offset:45056
    v_mfma_f32_32x32x16_bf16 a[80:95], v[36:39], v[64:67], a[80:95]
    ds_read_b128 v[52:55], v19 offset:53248
    v_mfma_f32_32x32x16_bf16 a[96:111], v[40:43], v[60:63], a[96:111]
    ds_read_b128 v[56:59], v19 offset:61440
    v_mfma_f32_32x32x16_bf16 a[112:127], v[40:43], v[64:67], a[112:127]
    s_waitcnt lgkmcnt(0)
    s_add_u32 m0, s25, 4096
    s_add_u32 s30, s48, 2097152
    buffer_load_dwordx4 v21, s[16:19], s30 offen lds
    buffer_load_dwordx4 v21, s[16:19], s30 offen offset:1024 lds
    s_waitcnt vmcnt(4)
    s_barrier
    s_mul_i32 s31, s24, 9216
    s_add_u32 m0, s31, 36864
    s_add_u32 s30, s26, 0
    v_add_u32 v26, s30, v22
    buffer_load_dwordx4 v26, s[12:15], s43 offen lds
    s_add_u32 m0, s31, 37888
    s_add_u32 s30, s26, 4096
    v_add_u32 v26, s30, v23
    buffer_load_dwordx4 v26, s[12:15], s43 offen lds
    s_add_u32 m0, s31, 38912
    s_add_u32 s30, s26, 8192
    v_add_u32 v26, s30, v24
    buffer_load_dwordx4 v26, s[12:15], s43 offen lds
    s_add_u32 m0, s31, 39936
    s_add_u32 s30, s26, 12288
    v_add_u32 v26, s30, v25
    buffer_load_dwordx4 v26, s[12:15], s43 offen lds
    s_add_u32 m0, s31, 40960
    s_add_u32 s30, s26, 16384
    v_add_u32 v26, s30, v22
    buffer_load_dwordx4 v26, s[12:15], s43 offen lds
    s_add_u32 m0, s31, 41984
    s_add_u32 s30, s26, 20480
    v_add_u32 v26, s30, v23
    buffer_load_dwordx4 v26, s[12:15], s43 offen lds
    s_add_u32 m0, s31, 43008
    s_add_u32 s30, s26, 24576
    v_add_u32 v26, s30, v24
    buffer_load_dwordx4 v26, s[12:15], s43 offen lds
    s_add_u32 m0, s31, 44032
    s_add_u32 s30, s26, 28672
    v_add_u32 v26, s30, v25
    buffer_load_dwordx4 v26, s[12:15], s43 offen lds
    s_add_u32 m0, s31, 45056
    s_add_u32 s30, s26, 32768
    v_add_u32 v26, s30, v22
    buffer_load_dwordx4 v26, s[12:15], s43 offen lds
    ds_read_b64_tr_b16 v[60:61], v20 offset:0
    v_mfma_f32_32x32x16_bf16 a[0:15], v[44:47], v[68:71], a[0:15]
    ds_read_b64_tr_b16 v[62:63], v20 offset:256
    v_mfma_f32_32x32x16_bf16 a[16:31], v[44:47], v[72:75], a[16:31]
    ds_read_b64_tr_b16 v[64:65], v20 offset:1024
    v_mfma_f32_32x32x16_bf16 a[32:47], v[48:51], v[68:71], a[32:47]
    ds_read_b64_tr_b16 v[66:67], v20 offset:1280
    v_mfma_f32_32x32x16_bf16 a[48:63], v[48:51], v[72:75], a[48:63]
    ds_read_b128 v[28:31], v10 offset:0
    v_mfma_f32_32x32x16_bf16 a[64:79], v[52:55], v[68:71], a[64:79]
    ds_read_b128 v[32:35], v10 offset:8192
    v_mfma_f32_32x32x16_bf16 a[80:95], v[52:55], v[72:75], a[80:95]
    ds_read_b128 v[36:39], v10 offset:16384
    v_mfma_f32_32x32x16_bf16 a[96:111], v[56:59], v[68:71], a[96:111]
    ds_read_b128 v[40:43], v10 offset:24576
    v_mfma_f32_32x32x16_bf16 a[112:127], v[56:59], v[72:75], a[112:127]
    s_waitcnt lgkmcnt(0)
    s_add_u32 m0, s25, 6144
    s_add_u32 s30, s48, 3145728
    buffer_load_dwordx4 v21, s[16:19], s30 offen lds
    buffer_load_dwordx4 v21, s[16:19], s30 offen offset:1024 lds
    s_waitcnt vmcnt(13)
    ds_read_b64_tr_b16 v[68:69], v20 offset:2048
    v_mfma_f32_32x32x16_bf16 a[0:15], v[28:31], v[60:63], a[0:15]
    ds_read_b64_tr_b16 v[70:71], v20 offset:2304
    v_mfma_f32_32x32x16_bf16 a[16:31], v[28:31], v[64:67], a[16:31]
    ds_read_b64_tr_b16 v[72:73], v20 offset:3072
    v_mfma_f32_32x32x16_bf16 a[32:47], v[32:35], v[60:63], a[32:47]
    ds_read_b64_tr_b16 v[74:75], v20 offset:3328
    v_mfma_f32_32x32x16_bf16 a[48:63], v[32:35], v[64:67], a[48:63]
    ds_read_b128 v[44:47], v12 offset:0
    v_mfma_f32_32x32x16_bf16 a[64:79], v[36:39], v[60:63], a[64:79]
    ds_read_b128 v[48:51], v12 offset:8192
    v_mfma_f32_32x32x16_bf16 a[80:95], v[36:39], v[64:67], a[80:95]
    ds_read_b128 v[52:55], v12 offset:16384
    v_mfma_f32_32x32x16_bf16 a[96:111], v[40:43], v[60:63], a[96:111]
    ds_read_b128 v[56:59], v12 offset:24576
    v_mfma_f32_32x32x16_bf16 a[112:127], v[40:43], v[64:67], a[112:127]
    s_waitcnt lgkmcnt(0)
    s_add_u32 m0, s25, 8192
    s_add_u32 s30, s48, 4194304
    buffer_load_dwordx4 v21, s[16:19], s30 offen lds
    buffer_load_dwordx4 v21, s[16:19], s30 offen offset:1024 lds
    s_waitcnt vmcnt(13)
    ds_read_b64_tr_b16 v[60:61], v20 offset:4096
    v_mfma_f32_32x32x16_bf16 a[0:15], v[44:47], v[68:71], a[0:15]
    ds_read_b64_tr_b16 v[62:63], v20 offset:4352
    v_mfma_f32_32x32x16_bf16 a[16:31], v[44:47], v[72:75], a[16:31]
    ds_read_b64_tr_b16 v[64:65], v20 offset:5120
    v_mfma_f32_32x32x16_bf16 a[32:47], v[48:51], v[68:71], a[32:47]
    ds_read_b64_tr_b16 v[66:67], v20 offset:5376
    v_mfma_f32_32x32x16_bf16 a[48:63], v[48:51], v[72:75], a[48:63]
    ds_read_b128 v[28:31], v14 offset:0
    v_mfma_f32_32x32x16_bf16 a[64:79], v[52:55], v[68:71], a[64:79]
    ds_read_b128 v[32:35], v14 offset:8192
    v_mfma_f32_32x32x16_bf16 a[80:95], v[52:55], v[72:75], a[80:95]
    ds_read_b128 v[36:39], v14 offset:16384
    v_mfma_f32_32x32x16_bf16 a[96:111], v[56:59], v[68:71], a[96:111]
    ds_read_b128 v[40:43], v14 offset:24576
    v_mfma_f32_32x32x16_bf16 a[112:127], v[56:59], v[72:75], a[112:127]
    s_waitcnt lgkmcnt(0)
    s_add_u32 m0, s25, 10240
    s_add_u32 s30, s49, 0
    buffer_load_dwordx4 v21, s[16:19], s30 offen lds
    buffer_load_dwordx4 v21, s[16:19], s30 offen offset:1024 lds
    s_waitcnt vmcnt(4)
    ds_read_b64_tr_b16 v[68:69], v20 offset:6144
    v_mfma_f32_32x32x16_bf16 a[0:15], v[28:31], v[60:63], a[0:15]
    ds_read_b64_tr_b16 v[70:71], v20 offset:6400
    v_mfma_f32_32x32x16_bf16 a[16:31], v[28:31], v[64:67], a[16:31]
    ds_read_b64_tr_b16 v[72:73], v20 offset:7168
    v_mfma_f32_32x32x16_bf16 a[32:47], v[32:35], v[60:63], a[32:47]
    ds_read_b64_tr_b16 v[74:75], v20 offset:7424
    v_mfma_f32_32x32x16_bf16 a[48:63], v[32:35], v[64:67], a[48:63]
    ds_read_b128 v[44:47], v16 offset:0
    v_mfma_f32_32x32x16_bf16 a[64:79], v[36:39], v[60:63], a[64:79]
    ds_read_b128 v[48:51], v16 offset:8192
    v_mfma_f32_32x32x16_bf16 a[80:95], v[36:39], v[64:67], a[80:95]
    ds_read_b128 v[52:55], v16 offset:16384
    v_mfma_f32_32x32x16_bf16 a[96:111], v[40:43], v[60:63], a[96:111]
    ds_read_b128 v[56:59], v16 offset:24576
    v_mfma_f32_32x32x16_bf16 a[112:127], v[40:43], v[64:67], a[112:127]
    s_waitcnt lgkmcnt(0)
    s_add_u32 m0, s25, 12288
    s_add_u32 s30, s49, 1048576
    buffer_load_dwordx4 v21, s[16:19], s30 offen lds
    buffer_load_dwordx4 v21, s[16:19], s30 offen offset:1024 lds
    s_waitcnt vmcnt(4)
    ds_read_b64_tr_b16 v[60:61], v20 offset:8192
    v_mfma_f32_32x32x16_bf16 a[0:15], v[44:47], v[68:71], a[0:15]
    ds_read_b64_tr_b16 v[62:63], v20 offset:8448
    v_mfma_f32_32x32x16_bf16 a[16:31], v[44:47], v[72:75], a[16:31]
    ds_read_b64_tr_b16 v[64:65], v20 offset:9216
    v_mfma_f32_32x32x16_bf16 a[32:47], v[48:51], v[68:71], a[32:47]
    ds_read_b64_tr_b16 v[66:67], v20 offset:9472
    v_mfma_f32_32x32x16_bf16 a[48:63], v[48:51], v[72:75], a[48:63]
    ds_read_b128 v[28:31], v18 offset:0
    v_mfma_f32_32x32x16_bf16 a[64:79], v[52:55], v[68:71], a[64:79]
    ds_read_b128 v[32:35], v18 offset:8192
    v_mfma_f32_32x32x16_bf16 a[80:95], v[52:55], v[72:75], a[80:95]
    ds_read_b128 v[36:39], v18 offset:16384
    v_mfma_f32_32x32x16_bf16 a[96:111], v[56:59], v[68:71], a[96:111]
    ds_read_b128 v[40:43], v18 offset:24576
    v_mfma_f32_32x32x16_bf16 a[112:127], v[56:59], v[72:75], a[112:127]
    s_waitcnt lgkmcnt(0)
    s_add_u32 m0, s25, 14336
    s_add_u32 s30, s49, 2097152
    buffer_load_dwordx4 v21, s[16:19], s30 offen lds
    buffer_load_dwordx4 v21, s[16:19], s30 offen offset:1024 lds
    s_waitcnt vmcnt(4)
    ds_read_b64_tr_b16 v[68:69], v20 offset:10240
    v_mfma_f32_32x32x16_bf16 a[0:15], v[28:31], v[60:63], a[0:15]
    ds_read_b64_tr_b16 v[70:71], v20 offset:10496
    v_mfma_f32_32x32x16_bf16 a[16:31], v[28:31], v[64:67], a[16:31]
    ds_read_b64_tr_b16 v[72:73], v20 offset:11264
    v_mfma_f32_32x32x16_bf16 a[32:47], v[32:35], v[60:63], a[32:47]
    ds_read_b64_tr_b16 v[74:75], v20 offset:11520
    v_mfma_f32_32x32x16_bf16 a[48:63], v[32:35], v[64:67], a[48:63]
    ds_read_b128 v[44:47], v11 offset:0
    v_mfma_f32_32x32x16_bf16 a[64:79], v[36:39], v[60:63], a[64:79]
    ds_read_b128 v[48:51], v11 offset:8192
    v_mfma_f32_32x32x16_bf16 a[80:95], v[36:39], v[64:67], a[80:95]
    ds_read_b128 v[52:55], v11 offset:16384
    v_mfma_f32_32x32x16_bf16 a[96:111], v[40:43], v[60:63], a[96:111]
    ds_read_b128 v[56:59], v11 offset:24576
    v_mfma_f32_32x32x16_bf16 a[112:127], v[40:43], v[64:67], a[112:127]
    s_waitcnt lgkmcnt(0)
    s_add_u32 m0, s25, 16384
    s_add_u32 s30, s49, 3145728
    buffer_load_dwordx4 v21, s[16:19], s30 offen lds
    buffer_load_dwordx4 v21, s[16:19], s30 offen offset:1024 lds
    s_waitcnt vmcnt(4)
    ds_read_b64_tr_b16 v[60:61], v20 offset:12288
    v_mfma_f32_32x32x16_bf16 a[0:15], v[44:47], v[68:71], a[0:15]
    ds_read_b64_tr_b16 v[62:63], v20 offset:12544
    v_mfma_f32_32x32x16_bf16 a[16:31], v[44:47], v[72:75], a[16:31]
    ds_read_b64_tr_b16 v[64:65], v20 offset:13312
    v_mfma_f32_32x32x16_bf16 a[32:47], v[48:51], v[68:71], a[32:47]
    ds_read_b64_tr_b16 v[66:67], v20 offset:13568
    v_mfma_f32_32x32x16_bf16 a[48:63], v[48:51], v[72:75], a[48:63]
    ds_read_b128 v[28:31], v13 offset:0
    v_mfma_f32_32x32x16_bf16 a[64:79], v[52:55], v[68:71], a[64:79]
    ds_read_b128 v[32:35], v13 offset:8192
    v_mfma_f32_32x32x16_bf16 a[80:95], v[52:55], v[72:75], a[80:95]
    ds_read_b128 v[36:39], v13 offset:16384
    v_mfma_f32_32x32x16_bf16 a[96:111], v[56:59], v[68:71], a[96:111]
    ds_read_b128 v[40:43], v13 offset:24576
    v_mfma_f32_32x32x16_bf16 a[112:127], v[56:59], v[72:75], a[112:127]
    s_waitcnt lgkmcnt(0)
    s_add_u32 m0, s25, 18432
    s_add_u32 s30, s49, 4194304
    buffer_load_dwordx4 v21, s[16:19], s30 offen lds
    buffer_load_dwordx4 v21, s[16:19], s30 offen offset:1024 lds
    s_waitcnt vmcnt(4)
    ds_read_b64_tr_b16 v[68:69], v20 offset:14336
    v_mfma_f32_32x32x16_bf16 a[0:15], v[28:31], v[60:63], a[0:15]
    ds_read_b64_tr_b16 v[70:71], v20 offset:14592
    v_mfma_f32_32x32x16_bf16 a[16:31], v[28:31], v[64:67], a[16:31]
    ds_read_b64_tr_b16 v[72:73], v20 offset:15360
    v_mfma_f32_32x32x16_bf16 a[32:47], v[32:35], v[60:63], a[32:47]
    ds_read_b64_tr_b16 v[74:75], v20 offset:15616
    v_mfma_f32_32x32x16_bf16 a[48:63], v[32:35], v[64:67], a[48:63]
    ds_read_b128 v[44:47], v15 offset:0
    v_mfma_f32_32x32x16_bf16 a[64:79], v[36:39], v[60:63], a[64:79]
    ds_read_b128 v[48:51], v15 offset:8192
    v_mfma_f32_32x32x16_bf16 a[80:95], v[36:39], v[64:67], a[80:95]
    ds_read_b128 v[52:55], v15 offset:16384
    v_mfma_f32_32x32x16_bf16 a[96:111], v[40:43], v[60:63], a[96:111]
    ds_read_b128 v[56:59], v15 offset:24576
    v_mfma_f32_32x32x16_bf16 a[112:127], v[40:43], v[64:67], a[112:127]
    s_waitcnt lgkmcnt(0)
    s_add_u32 m0, s25, 0
    s_add_u32 s30, s50, 0
    buffer_load_dwordx4 v21, s[16:19], s30 offen lds
    buffer_load_dwordx4 v21, s[16:19], s30 offen offset:1024 lds
    s_waitcnt vmcnt(4)
    ds_read_b64_tr_b16 v[60:61], v20 offset:16384
    v_mfma_f32_32x32x16_bf16 a[0:15], v[44:47], v[68:71], a[0:15]
    ds_read_b64_tr_b16 v[62:63], v20 offset:16640
    v_mfma_f32_32x32x16_bf16 a[16:31], v[44:47], v[72:75], a[16:31]
    ds_read_b64_tr_b16 v[64:65], v20 offset:17408
    v_mfma_f32_32x32x16_bf16 a[32:47], v[48:51], v[68:71], a[32:47]
    ds_read_b64_tr_b16 v[66:67], v20 offset:17664
    v_mfma_f32_32x32x16_bf16 a[48:63], v[48:51], v[72:75], a[48:63]
    ds_read_b128 v[28:31], v17 offset:0
    v_mfma_f32_32x32x16_bf16 a[64:79], v[52:55], v[68:71], a[64:79]
    ds_read_b128 v[32:35], v17 offset:8192
    v_mfma_f32_32x32x16_bf16 a[80:95], v[52:55], v[72:75], a[80:95]
    ds_read_b128 v[36:39], v17 offset:16384
    v_mfma_f32_32x32x16_bf16 a[96:111], v[56:59], v[68:71], a[96:111]
    ds_read_b128 v[40:43], v17 offset:24576
    v_mfma_f32_32x32x16_bf16 a[112:127], v[56:59], v[72:75], a[112:127]
    s_waitcnt lgkmcnt(0)
    s_add_u32 m0, s25, 2048
    s_add_u32 s30, s50, 1048576
    buffer_load_dwordx4 v21, s[16:19], s30 offen lds
    buffer_load_dwordx4 v21, s[16:19], s30 offen offset:1024 lds
    s_waitcnt vmcnt(4)
    ds_read_b64_tr_b16 v[68:69], v20 offset:18432
    v_mfma_f32_32x32x16_bf16 a[0:15], v[28:31], v[60:63], a[0:15]
    ds_read_b64_tr_b16 v[70:71], v20 offset:18688
    v_mfma_f32_32x32x16_bf16 a[16:31], v[28:31], v[64:67], a[16:31]
    ds_read_b64_tr_b16 v[72:73], v20 offset:19456
    v_mfma_f32_32x32x16_bf16 a[32:47], v[32:35], v[60:63], a[32:47]
    ds_read_b64_tr_b16 v[74:75], v20 offset:19712
    v_mfma_f32_32x32x16_bf16 a[48:63], v[32:35], v[64:67], a[48:63]
    ds_read_b128 v[44:47], v19 offset:0
    v_mfma_f32_32x32x16_bf16 a[64:79], v[36:39], v[60:63], a[64:79]
    ds_read_b128 v[48:51], v19 offset:8192
    v_mfma_f32_32x32x16_bf16 a[80:95], v[36:39], v[64:67], a[80:95]
    ds_read_b128 v[52:55], v19 offset:16384
    v_mfma_f32_32x32x16_bf16 a[96:111], v[40:43], v[60:63], a[96:111]
    ds_read_b128 v[56:59], v19 offset:24576
    v_mfma_f32_32x32x16_bf16 a[112:127], v[40:43], v[64:67], a[112:127]
    s_waitcnt lgkmcnt(0)
    s_add_u32 m0, s25, 4096
    s_add_u32 s30, s50, 2097152
    buffer_load_dwordx4 v21, s[16:19], s30 offen lds
    buffer_load_dwordx4 v21, s[16:19], s30 offen offset:1024 lds
    s_waitcnt vmcnt(4)
    s_barrier
    ds_read_b64_tr_b16 v[60:61], v20 offset:0
    v_mfma_f32_32x32x16_bf16 a[0:15], v[44:47], v[68:71], a[0:15]
    ds_read_b64_tr_b16 v[62:63], v20 offset:256
    v_mfma_f32_32x32x16_bf16 a[16:31], v[44:47], v[72:75], a[16:31]
    ds_read_b64_tr_b16 v[64:65], v20 offset:1024
    v_mfma_f32_32x32x16_bf16 a[32:47], v[48:51], v[68:71], a[32:47]
    ds_read_b64_tr_b16 v[66:67], v20 offset:1280
    v_mfma_f32_32x32x16_bf16 a[48:63], v[48:51], v[72:75], a[48:63]
    ds_read_b128 v[28:31], v10 offset:36864
    v_mfma_f32_32x32x16_bf16 a[64:79], v[52:55], v[68:71], a[64:79]
    ds_read_b128 v[32:35], v10 offset:45056
    v_mfma_f32_32x32x16_bf16 a[80:95], v[52:55], v[72:75], a[80:95]
    ds_read_b128 v[36:39], v10 offset:53248
    v_mfma_f32_32x32x16_bf16 a[96:111], v[56:59], v[68:71], a[96:111]
    ds_read_b128 v[40:43], v10 offset:61440
    v_mfma_f32_32x32x16_bf16 a[112:127], v[56:59], v[72:75], a[112:127]
    s_waitcnt lgkmcnt(0)
    s_add_u32 m0, s25, 6144
    s_add_u32 s30, s50, 3145728
    buffer_load_dwordx4 v21, s[16:19], s30 offen lds
    buffer_load_dwordx4 v21, s[16:19], s30 offen offset:1024 lds
    s_waitcnt vmcnt(4)
    ds_read_b64_tr_b16 v[68:69], v20 offset:2048
    v_mfma_f32_32x32x16_bf16 a[0:15], v[28:31], v[60:63], a[0:15]
    ds_read_b64_tr_b16 v[70:71], v20 offset:2304
    v_mfma_f32_32x32x16_bf16 a[16:31], v[28:31], v[64:67], a[16:31]
    ds_read_b64_tr_b16 v[72:73], v20 offset:3072
    v_mfma_f32_32x32x16_bf16 a[32:47], v[32:35], v[60:63], a[32:47]
    ds_read_b64_tr_b16 v[74:75], v20 offset:3328
    v_mfma_f32_32x32x16_bf16 a[48:63], v[32:35], v[64:67], a[48:63]
    ds_read_b128 v[44:47], v12 offset:36864
    v_mfma_f32_32x32x16_bf16 a[64:79], v[36:39], v[60:63], a[64:79]
    ds_read_b128 v[48:51], v12 offset:45056
    v_mfma_f32_32x32x16_bf16 a[80:95], v[36:39], v[64:67], a[80:95]
    ds_read_b128 v[52:55], v12 offset:53248
    v_mfma_f32_32x32x16_bf16 a[96:111], v[40:43], v[60:63], a[96:111]
    ds_read_b128 v[56:59], v12 offset:61440
    v_mfma_f32_32x32x16_bf16 a[112:127], v[40:43], v[64:67], a[112:127]
    s_waitcnt lgkmcnt(0)
    s_add_u32 m0, s25, 8192
    s_add_u32 s30, s50, 4194304
    buffer_load_dwordx4 v21, s[16:19], s30 offen lds
    buffer_load_dwordx4 v21, s[16:19], s30 offen offset:1024 lds
    s_waitcnt vmcnt(4)
    ds_read_b64_tr_b16 v[60:61], v20 offset:4096
    v_mfma_f32_32x32x16_bf16 a[0:15], v[44:47], v[68:71], a[0:15]
    ds_read_b64_tr_b16 v[62:63], v20 offset:4352
    v_mfma_f32_32x32x16_bf16 a[16:31], v[44:47], v[72:75], a[16:31]
    ds_read_b64_tr_b16 v[64:65], v20 offset:5120
    v_mfma_f32_32x32x16_bf16 a[32:47], v[48:51], v[68:71], a[32:47]
    ds_read_b64_tr_b16 v[66:67], v20 offset:5376
    v_mfma_f32_32x32x16_bf16 a[48:63], v[48:51], v[72:75], a[48:63]
    ds_read_b128 v[28:31], v14 offset:36864
    v_mfma_f32_32x32x16_bf16 a[64:79], v[52:55], v[68:71], a[64:79]
    ds_read_b128 v[32:35], v14 offset:45056
    v_mfma_f32_32x32x16_bf16 a[80:95], v[52:55], v[72:75], a[80:95]
    ds_read_b128 v[36:39], v14 offset:53248
    v_mfma_f32_32x32x16_bf16 a[96:111], v[56:59], v[68:71], a[96:111]
    ds_read_b128 v[40:43], v14 offset:61440
    v_mfma_f32_32x32x16_bf16 a[112:127], v[56:59], v[72:75], a[112:127]
    s_waitcnt lgkmcnt(0)
    s_add_u32 m0, s25, 10240
    s_add_u32 s30, s51, 0
    buffer_load_dwordx4 v21, s[16:19], s30 offen lds
    buffer_load_dwordx4 v21, s[16:19], s30 offen offset:1024 lds
    s_waitcnt vmcnt(4)
    ds_read_b64_tr_b16 v[68:69], v20 offset:6144
    v_mfma_f32_32x32x16_bf16 a[0:15], v[28:31], v[60:63], a[0:15]
    ds_read_b64_tr_b16 v[70:71], v20 offset:6400
    v_mfma_f32_32x32x16_bf16 a[16:31], v[28:31], v[64:67], a[16:31]
    ds_read_b64_tr_b16 v[72:73], v20 offset:7168
    v_mfma_f32_32x32x16_bf16 a[32:47], v[32:35], v[60:63], a[32:47]
    ds_read_b64_tr_b16 v[74:75], v20 offset:7424
    v_mfma_f32_32x32x16_bf16 a[48:63], v[32:35], v[64:67], a[48:63]
    ds_read_b128 v[44:47], v16 offset:36864
    v_mfma_f32_32x32x16_bf16 a[64:79], v[36:39], v[60:63], a[64:79]
    ds_read_b128 v[48:51], v16 offset:45056
    v_mfma_f32_32x32x16_bf16 a[80:95], v[36:39], v[64:67], a[80:95]
    ds_read_b128 v[52:55], v16 offset:53248
    v_mfma_f32_32x32x16_bf16 a[96:111], v[40:43], v[60:63], a[96:111]
    ds_read_b128 v[56:59], v16 offset:61440
    v_mfma_f32_32x32x16_bf16 a[112:127], v[40:43], v[64:67], a[112:127]
    s_waitcnt lgkmcnt(0)
    s_add_u32 m0, s25, 12288
    s_add_u32 s30, s51, 1048576
    buffer_load_dwordx4 v21, s[16:19], s30 offen lds
    buffer_load_dwordx4 v21, s[16:19], s30 offen offset:1024 lds
    s_waitcnt vmcnt(4)
    ds_read_b64_tr_b16 v[60:61], v20 offset:8192
    v_mfma_f32_32x32x16_bf16 a[0:15], v[44:47], v[68:71], a[0:15]
    ds_read_b64_tr_b16 v[62:63], v20 offset:8448
    v_mfma_f32_32x32x16_bf16 a[16:31], v[44:47], v[72:75], a[16:31]
    ds_read_b64_tr_b16 v[64:65], v20 offset:9216
    v_mfma_f32_32x32x16_bf16 a[32:47], v[48:51], v[68:71], a[32:47]
    ds_read_b64_tr_b16 v[66:67], v20 offset:9472
    v_mfma_f32_32x32x16_bf16 a[48:63], v[48:51], v[72:75], a[48:63]
    ds_read_b128 v[28:31], v18 offset:36864
    v_mfma_f32_32x32x16_bf16 a[64:79], v[52:55], v[68:71], a[64:79]
    ds_read_b128 v[32:35], v18 offset:45056
    v_mfma_f32_32x32x16_bf16 a[80:95], v[52:55], v[72:75], a[80:95]
    ds_read_b128 v[36:39], v18 offset:53248
    v_mfma_f32_32x32x16_bf16 a[96:111], v[56:59], v[68:71], a[96:111]
    ds_read_b128 v[40:43], v18 offset:61440
    v_mfma_f32_32x32x16_bf16 a[112:127], v[56:59], v[72:75], a[112:127]
    s_waitcnt lgkmcnt(0)
    s_add_u32 m0, s25, 14336
    s_add_u32 s30, s51, 2097152
    buffer_load_dwordx4 v21, s[16:19], s30 offen lds
    buffer_load_dwordx4 v21, s[16:19], s30 offen offset:1024 lds
    s_waitcnt vmcnt(4)
    ds_read_b64_tr_b16 v[68:69], v20 offset:10240
    v_mfma_f32_32x32x16_bf16 a[0:15], v[28:31], v[60:63], a[0:15]
    ds_read_b64_tr_b16 v[70:71], v20 offset:10496
    v_mfma_f32_32x32x16_bf16 a[16:31], v[28:31], v[64:67], a[16:31]
    ds_read_b64_tr_b16 v[72:73], v20 offset:11264
    v_mfma_f32_32x32x16_bf16 a[32:47], v[32:35], v[60:63], a[32:47]
    ds_read_b64_tr_b16 v[74:75], v20 offset:11520
    v_mfma_f32_32x32x16_bf16 a[48:63], v[32:35], v[64:67], a[48:63]
    ds_read_b128 v[44:47], v11 offset:36864
    v_mfma_f32_32x32x16_bf16 a[64:79], v[36:39], v[60:63], a[64:79]
    ds_read_b128 v[48:51], v11 offset:45056
    v_mfma_f32_32x32x16_bf16 a[80:95], v[36:39], v[64:67], a[80:95]
    ds_read_b128 v[52:55], v11 offset:53248
    v_mfma_f32_32x32x16_bf16 a[96:111], v[40:43], v[60:63], a[96:111]
    ds_read_b128 v[56:59], v11 offset:61440
    v_mfma_f32_32x32x16_bf16 a[112:127], v[40:43], v[64:67], a[112:127]
    s_waitcnt lgkmcnt(0)
    s_add_u32 m0, s25, 16384
    s_add_u32 s30, s51, 3145728
    buffer_load_dwordx4 v21, s[16:19], s30 offen lds
    buffer_load_dwordx4 v21, s[16:19], s30 offen offset:1024 lds
    s_waitcnt vmcnt(4)
    ds_read_b64_tr_b16 v[60:61], v20 offset:12288
    v_mfma_f32_32x32x16_bf16 a[0:15], v[44:47], v[68:71], a[0:15]
    ds_read_b64_tr_b16 v[62:63], v20 offset:12544
    v_mfma_f32_32x32x16_bf16 a[16:31], v[44:47], v[72:75], a[16:31]
    ds_read_b64_tr_b16 v[64:65], v20 offset:13312
    v_mfma_f32_32x32x16_bf16 a[32:47], v[48:51], v[68:71], a[32:47]
    ds_read_b64_tr_b16 v[66:67], v20 offset:13568
    v_mfma_f32_32x32x16_bf16 a[48:63], v[48:51], v[72:75], a[48:63]
    ds_read_b128 v[28:31], v13 offset:36864
    v_mfma_f32_32x32x16_bf16 a[64:79], v[52:55], v[68:71], a[64:79]
    ds_read_b128 v[32:35], v13 offset:45056
    v_mfma_f32_32x32x16_bf16 a[80:95], v[52:55], v[72:75], a[80:95]
    ds_read_b128 v[36:39], v13 offset:53248
    v_mfma_f32_32x32x16_bf16 a[96:111], v[56:59], v[68:71], a[96:111]
    ds_read_b128 v[40:43], v13 offset:61440
    v_mfma_f32_32x32x16_bf16 a[112:127], v[56:59], v[72:75], a[112:127]
    s_waitcnt lgkmcnt(0)
    s_add_u32 m0, s25, 18432
    s_add_u32 s30, s51, 4194304
    buffer_load_dwordx4 v21, s[16:19], s30 offen lds
    buffer_load_dwordx4 v21, s[16:19], s30 offen offset:1024 lds
    s_waitcnt vmcnt(4)
    ds_read_b64_tr_b16 v[68:69], v20 offset:14336
    v_mfma_f32_32x32x16_bf16 a[0:15], v[28:31], v[60:63], a[0:15]
    ds_read_b64_tr_b16 v[70:71], v20 offset:14592
    v_mfma_f32_32x32x16_bf16 a[16:31], v[28:31], v[64:67], a[16:31]
    ds_read_b64_tr_b16 v[72:73], v20 offset:15360
    v_mfma_f32_32x32x16_bf16 a[32:47], v[32:35], v[60:63], a[32:47]
    ds_read_b64_tr_b16 v[74:75], v20 offset:15616
    v_mfma_f32_32x32x16_bf16 a[48:63], v[32:35], v[64:67], a[48:63]
    ds_read_b128 v[44:47], v15 offset:36864
    v_mfma_f32_32x32x16_bf16 a[64:79], v[36:39], v[60:63], a[64:79]
    ds_read_b128 v[48:51], v15 offset:45056
    v_mfma_f32_32x32x16_bf16 a[80:95], v[36:39], v[64:67], a[80:95]
    ds_read_b128 v[52:55], v15 offset:53248
    v_mfma_f32_32x32x16_bf16 a[96:111], v[40:43], v[60:63], a[96:111]
    ds_read_b128 v[56:59], v15 offset:61440
    v_mfma_f32_32x32x16_bf16 a[112:127], v[40:43], v[64:67], a[112:127]
    s_waitcnt lgkmcnt(0)
    s_waitcnt vmcnt(2)
    ds_read_b64_tr_b16 v[60:61], v20 offset:16384
    v_mfma_f32_32x32x16_bf16 a[0:15], v[44:47], v[68:71], a[0:15]
    ds_read_b64_tr_b16 v[62:63], v20 offset:16640
    v_mfma_f32_32x32x16_bf16 a[16:31], v[44:47], v[72:75], a[16:31]
    ds_read_b64_tr_b16 v[64:65], v20 offset:17408
    v_mfma_f32_32x32x16_bf16 a[32:47], v[48:51], v[68:71], a[32:47]
    ds_read_b64_tr_b16 v[66:67], v20 offset:17664
    v_mfma_f32_32x32x16_bf16 a[48:63], v[48:51], v[72:75], a[48:63]
    ds_read_b128 v[28:31], v17 offset:36864
    v_mfma_f32_32x32x16_bf16 a[64:79], v[52:55], v[68:71], a[64:79]
    ds_read_b128 v[32:35], v17 offset:45056
    v_mfma_f32_32x32x16_bf16 a[80:95], v[52:55], v[72:75], a[80:95]
    ds_read_b128 v[36:39], v17 offset:53248
    v_mfma_f32_32x32x16_bf16 a[96:111], v[56:59], v[68:71], a[96:111]
    ds_read_b128 v[40:43], v17 offset:61440
    v_mfma_f32_32x32x16_bf16 a[112:127], v[56:59], v[72:75], a[112:127]
    s_waitcnt lgkmcnt(0)
    s_waitcnt vmcnt(0)
    ds_read_b64_tr_b16 v[68:69], v20 offset:18432
    v_mfma_f32_32x32x16_bf16 a[0:15], v[28:31], v[60:63], a[0:15]
    ds_read_b64_tr_b16 v[70:71], v20 offset:18688
    v_mfma_f32_32x32x16_bf16 a[16:31], v[28:31], v[64:67], a[16:31]
    ds_read_b64_tr_b16 v[72:73], v20 offset:19456
    v_mfma_f32_32x32x16_bf16 a[32:47], v[32:35], v[60:63], a[32:47]
    ds_read_b64_tr_b16 v[74:75], v20 offset:19712
    v_mfma_f32_32x32x16_bf16 a[48:63], v[32:35], v[64:67], a[48:63]
    ds_read_b128 v[44:47], v19 offset:36864
    v_mfma_f32_32x32x16_bf16 a[64:79], v[36:39], v[60:63], a[64:79]
    ds_read_b128 v[48:51], v19 offset:45056
    v_mfma_f32_32x32x16_bf16 a[80:95], v[36:39], v[64:67], a[80:95]
    ds_read_b128 v[52:55], v19 offset:53248
    v_mfma_f32_32x32x16_bf16 a[96:111], v[40:43], v[60:63], a[96:111]
    ds_read_b128 v[56:59], v19 offset:61440
    v_mfma_f32_32x32x16_bf16 a[112:127], v[40:43], v[64:67], a[112:127]
    s_waitcnt lgkmcnt(0)
    v_mfma_f32_32x32x16_bf16 a[0:15], v[44:47], v[68:71], a[0:15]
    v_mfma_f32_32x32x16_bf16 a[16:31], v[44:47], v[72:75], a[16:31]
    v_mfma_f32_32x32x16_bf16 a[32:47], v[48:51], v[68:71], a[32:47]
    v_mfma_f32_32x32x16_bf16 a[48:63], v[48:51], v[72:75], a[48:63]
    v_mfma_f32_32x32x16_bf16 a[64:79], v[52:55], v[68:71], a[64:79]
    v_mfma_f32_32x32x16_bf16 a[80:95], v[52:55], v[72:75], a[80:95]
    v_mfma_f32_32x32x16_bf16 a[96:111], v[56:59], v[68:71], a[96:111]
    v_mfma_f32_32x32x16_bf16 a[112:127], v[56:59], v[72:75], a[112:127]
    s_nop 15
    s_nop 15
    s_waitcnt vmcnt(0) lgkmcnt(0)
    s_barrier
    v_lshlrev_b32 v5, 4, v2
    s_lshl_b32 s30, s24, 15
    v_add_u32 v5, s30, v5
    v_lshlrev_b32 v6, 4, v2
    s_lshl_b32 s30, s24, 13
    v_add_u32 v6, s30, v6
    v_add_u32 v7, 0x10000, v6
    s_cmp_eq_u32 s24, 1
    s_cbranch_scc1 L_ep1
    s_cmp_eq_u32 s24, 2
    s_cbranch_scc1 L_ep2
    s_cmp_eq_u32 s24, 3
    s_cbranch_scc1 L_ep3
L_ep0:
    ds_write_b128 v5, a[32:35] offset:8192
    ds_write_b128 v5, a[36:39] offset:9216
    ds_write_b128 v5, a[40:43] offset:10240
    ds_write_b128 v5, a[44:47] offset:11264
    ds_write_b128 v5, a[48:51] offset:12288
    ds_write_b128 v5, a[52:55] offset:13312
    ds_write_b128 v5, a[56:59] offset:14336
    ds_write_b128 v5, a[60:63] offset:15360
    ds_write_b128 v5, a[64:67] offset:16384
    ds_write_b128 v5, a[68:71] offset:17408
    ds_write_b128 v5, a[72:75] offset:18432
    ds_write_b128 v5, a[76:79] offset:19456
    ds_write_b128 v5, a[80:83] offset:20480
    ds_write_b128 v5, a[84:87] offset:21504
    ds_write_b128 v5, a[88:91] offset:22528
    ds_write_b128 v5, a[92:95] offset:23552
    ds_write_b128 v5, a[96:99] offset:24576
    ds_write_b128 v5, a[100:103] offset:25600
    ds_write_b128 v5, a[104:107] offset:26624
    ds_write_b128 v5, a[108:111] offset:27648
    ds_write_b128 v5, a[112:115] offset:28672
    ds_write_b128 v5, a[116:119] offset:29696
    ds_write_b128 v5, a[120:123] offset:30720
    ds_write_b128 v5, a[124:127] offset:31744
    v_accvgpr_read_b32 v76, a0
    v_accvgpr_read_b32 v77, a1
    v_accvgpr_read_b32 v78, a2
    v_accvgpr_read_b32 v79, a3
    v_accvgpr_read_b32 v80, a4
    v_accvgpr_read_b32 v81, a5
    v_accvgpr_read_b32 v82, a6
    v_accvgpr_read_b32 v83, a7
    v_accvgpr_read_b32 v84, a8
    v_accvgpr_read_b32 v85, a9
    v_accvgpr_read_b32 v86, a10
    v_accvgpr_read_b32 v87, a11
    v_accvgpr_read_b32 v88, a12
    v_accvgpr_read_b32 v89, a13
    v_accvgpr_read_b32 v90, a14
    v_accvgpr_read_b32 v91, a15
    v_accvgpr_read_b32 v92, a16
    v_accvgpr_read_b32 v93, a17
    v_accvgpr_read_b32 v94, a18
    v_accvgpr_read_b32 v95, a19
    v_accvgpr_read_b32 v96, a20
    v_accvgpr_read_b32 v97, a21
    v_accvgpr_read_b32 v98, a22
    v_accvgpr_read_b32 v99, a23
    v_accvgpr_read_b32 v100, a24
    v_accvgpr_read_b32 v101, a25
    v_accvgpr_read_b32 v102, a26
    v_accvgpr_read_b32 v103, a27
    v_accvgpr_read_b32 v104, a28
    v_accvgpr_read_b32 v105, a29
    v_accvgpr_read_b32 v106, a30
    v_accvgpr_read_b32 v107, a31
    s_waitcnt lgkmcnt(0)
    s_barrier
    ds_read_b128 v[108:111], v6 offset:32768
    ds_read_b128 v[112:115], v6 offset:33792
    ds_read_b128 v[116:119], v6 offset:34816
    ds_read_b128 v[120:123], v6 offset:35840
    ds_read_b128 v[124:127], v7 offset:0
    ds_read_b128 v[128:131], v7 offset:1024
    ds_read_b128 v[132:135], v7 offset:2048
    ds_read_b128 v[136:139], v7 offset:3072
    ds_read_b128 v[140:143], v7 offset:32768
    ds_read_b128 v[144:147], v7 offset:33792
    ds_read_b128 v[148:151], v7 offset:34816
    ds_read_b128 v[152:155], v7 offset:35840
    s_waitcnt lgkmcnt(0)
    v_pk_add_f32 v[108:109], v[108:109], v[124:125]
    v_pk_add_f32 v[76:77], v[76:77], v[140:141]
    v_pk_add_f32 v[110:111], v[110:111], v[126:127]
    v_pk_add_f32 v[78:79], v[78:79], v[142:143]
    v_pk_add_f32 v[112:113], v[112:113], v[128:129]
    v_pk_add_f32 v[80:81], v[80:81], v[144:145]
    v_pk_add_f32 v[114:115], v[114:115], v[130:131]
    v_pk_add_f32 v[82:83], v[82:83], v[146:147]
    v_pk_add_f32 v[116:117], v[116:117], v[132:133]
    v_pk_add_f32 v[84:85], v[84:85], v[148:149]
    v_pk_add_f32 v[118:119], v[118:119], v[134:135]
    v_pk_add_f32 v[86:87], v[86:87], v[150:151]
    v_pk_add_f32 v[120:121], v[120:121], v[136:137]
    v_pk_add_f32 v[88:89], v[88:89], v[152:153]
    v_pk_add_f32 v[122:123], v[122:123], v[138:139]
    v_pk_add_f32 v[90:91], v[90:91], v[154:155]
    v_pk_add_f32 v[76:77], v[76:77], v[108:109]
    v_pk_add_f32 v[78:79], v[78:79], v[110:111]
    v_pk_add_f32 v[80:81], v[80:81], v[112:113]
    v_pk_add_f32 v[82:83], v[82:83], v[114:115]
    v_pk_add_f32 v[84:85], v[84:85], v[116:117]
    v_pk_add_f32 v[86:87], v[86:87], v[118:119]
    v_pk_add_f32 v[88:89], v[88:89], v[120:121]
    v_pk_add_f32 v[90:91], v[90:91], v[122:123]
    ds_read_b128 v[108:111], v6 offset:36864
    ds_read_b128 v[112:115], v6 offset:37888
    ds_read_b128 v[116:119], v6 offset:38912
    ds_read_b128 v[120:123], v6 offset:39936
    ds_read_b128 v[124:127], v7 offset:4096
    ds_read_b128 v[128:131], v7 offset:5120
    ds_read_b128 v[132:135], v7 offset:6144
    ds_read_b128 v[136:139], v7 offset:7168
    ds_read_b128 v[140:143], v7 offset:36864
    ds_read_b128 v[144:147], v7 offset:37888
    ds_read_b128 v[148:151], v7 offset:38912
    ds_read_b128 v[152:155], v7 offset:39936
    s_waitcnt lgkmcnt(0)
    v_pk_add_f32 v[108:109], v[108:109], v[124:125]
    v_pk_add_f32 v[92:93], v[92:93], v[140:141]
    v_pk_add_f32 v[110:111], v[110:111], v[126:127]
    v_pk_add_f32 v[94:95], v[94:95], v[142:143]
    v_pk_add_f32 v[112:113], v[112:113], v[128:129]
    v_pk_add_f32 v[96:97], v[96:97], v[144:145]
    v_pk_add_f32 v[114:115], v[114:115], v[130:131]
    v_pk_add_f32 v[98:99], v[98:99], v[146:147]
    v_pk_add_f32 v[116:117], v[116:117], v[132:133]
    v_pk_add_f32 v[100:101], v[100:101], v[148:149]
    v_pk_add_f32 v[118:119], v[118:119], v[134:135]
    v_pk_add_f32 v[102:103], v[102:103], v[150:151]
    v_pk_add_f32 v[120:121], v[120:121], v[136:137]
    v_pk_add_f32 v[104:105], v[104:105], v[152:153]
    v_pk_add_f32 v[122:123], v[122:123], v[138:139]
    v_pk_add_f32 v[106:107], v[106:107], v[154:155]
    v_pk_add_f32 v[92:93], v[92:93], v[108:109]
    v_pk_add_f32 v[94:95], v[94:95], v[110:111]
    v_pk_add_f32 v[96:97], v[96:97], v[112:113]
    v_pk_add_f32 v[98:99], v[98:99], v[114:115]
    v_pk_add_f32 v[100:101], v[100:101], v[116:117]
    v_pk_add_f32 v[102:103], v[102:103], v[118:119]
    v_pk_add_f32 v[104:105], v[104:105], v[120:121]
    v_pk_add_f32 v[106:107], v[106:107], v[122:123]
    s_branch L_act
L_ep1:
    ds_write_b128 v5, a[0:3] offset:0
    ds_write_b128 v5, a[4:7] offset:1024
    ds_write_b128 v5, a[8:11] offset:2048
    ds_write_b128 v5, a[12:15] offset:3072
    ds_write_b128 v5, a[16:19] offset:4096
    ds_write_b128 v5, a[20:23] offset:5120
    ds_write_b128 v5, a[24:27] offset:6144
    ds_write_b128 v5, a[28:31] offset:7168
    ds_write_b128 v5, a[64:67] offset:16384
    ds_write_b128 v5, a[68:71] offset:17408
    ds_write_b128 v5, a[72:75] offset:18432
    ds_write_b128 v5, a[76:79] offset:19456
    ds_write_b128 v5, a[80:83] offset:20480
    ds_write_b128 v5, a[84:87] offset:21504
    ds_write_b128 v5, a[88:91] offset:22528
    ds_write_b128 v5, a[92:95] offset:23552
    ds_write_b128 v5, a[96:99] offset:24576
    ds_write_b128 v5, a[100:103] offset:25600
    ds_write_b128 v5, a[104:107] offset:26624
    ds_write_b128 v5, a[108:111] offset:27648
    ds_write_b128 v5, a[112:115] offset:28672
    ds_write_b128 v5, a[116:119] offset:29696
    ds_write_b128 v5, a[120:123] offset:30720
    ds_write_b128 v5, a[124:127] offset:31744
    v_accvgpr_read_b32 v76, a32
    v_accvgpr_read_b32 v77, a33
    v_accvgpr_read_b32 v78, a34
    v_accvgpr_read_b32 v79, a35
    v_accvgpr_read_b32 v80, a36
    v_accvgpr_read_b32 v81, a37
    v_accvgpr_read_b32 v82, a38
    v_accvgpr_read_b32 v83, a39
    v_accvgpr_read_b32 v84, a40
    v_accvgpr_read_b32 v85, a41
    v_accvgpr_read_b32 v86, a42
    v_accvgpr_read_b32 v87, a43
    v_accvgpr_read_b32 v88, a44
    v_accvgpr_read_b32 v89, a45
    v_accvgpr_read_b32 v90, a46
    v_accvgpr_read_b32 v91, a47
    v_accvgpr_read_b32 v92, a48
    v_accvgpr_read_b32 v93, a49
    v_accvgpr_read_b32 v94, a50
    v_accvgpr_read_b32 v95, a51
    v_accvgpr_read_b32 v96, a52
    v_accvgpr_read_b32 v97, a53
    v_accvgpr_read_b32 v98, a54
    v_accvgpr_read_b32 v99, a55
    v_accvgpr_read_b32 v100, a56
    v_accvgpr_read_b32 v101, a57
    v_accvgpr_read_b32 v102, a58
    v_accvgpr_read_b32 v103, a59
    v_accvgpr_read_b32 v104, a60
    v_accvgpr_read_b32 v105, a61
    v_accvgpr_read_b32 v106, a62
    v_accvgpr_read_b32 v107, a63
    s_waitcnt lgkmcnt(0)
    s_barrier
    ds_read_b128 v[108:111], v6 offset:0
    ds_read_b128 v[112:115], v6 offset:1024
    ds_read_b128 v[116:119], v6 offset:2048
    ds_read_b128 v[120:123], v6 offset:3072
    ds_read_b128 v[124:127], v7 offset:0
    ds_read_b128 v[128:131], v7 offset:1024
    ds_read_b128 v[132:135], v7 offset:2048
    ds_read_b128 v[136:139], v7 offset:3072
    ds_read_b128 v[140:143], v7 offset:32768
    ds_read_b128 v[144:147], v7 offset:33792
    ds_read_b128 v[148:151], v7 offset:34816
    ds_read_b128 v[152:155], v7 offset:35840
    s_waitcnt lgkmcnt(0)
    v_pk_add_f32 v[108:109], v[108:109], v[124:125]
    v_pk_add_f32 v[76:77], v[76:77], v[140:141]
    v_pk_add_f32 v[110:111], v[110:111], v[126:127]
    v_pk_add_f32 v[78:79], v[78:79], v[142:143]
    v_pk_add_f32 v[112:113], v[112:113], v[128:129]
    v_pk_add_f32 v[80:81], v[80:81], v[144:145]
    v_pk_add_f32 v[114:115], v[114:115], v[130:131]
    v_pk_add_f32 v[82:83], v[82:83], v[146:147]
    v_pk_add_f32 v[116:117], v[116:117], v[132:133]
    v_pk_add_f32 v[84:85], v[84:85], v[148:149]
    v_pk_add_f32 v[118:119], v[118:119], v[134:135]
    v_pk_add_f32 v[86:87], v[86:87], v[150:151]
    v_pk_add_f32 v[120:121], v[120:121], v[136:137]
    v_pk_add_f32 v[88:89], v[88:89], v[152:153]
    v_pk_add_f32 v[122:123], v[122:123], v[138:139]
    v_pk_add_f32 v[90:91], v[90:91], v[154:155]
    v_pk_add_f32 v[76:77], v[76:77], v[108:109]
    v_pk_add_f32 v[78:79], v[78:79], v[110:111]
    v_pk_add_f32 v[80:81], v[80:81], v[112:113]
    v_pk_add_f32 v[82:83], v[82:83], v[114:115]
    v_pk_add_f32 v[84:85], v[84:85], v[116:117]
    v_pk_add_f32 v[86:87], v[86:87], v[118:119]
    v_pk_add_f32 v[88:89], v[88:89], v[120:121]
    v_pk_add_f32 v[90:91], v[90:91], v[122:123]
    ds_read_b128 v[108:111], v6 offset:4096
    ds_read_b128 v[112:115], v6 offset:5120
    ds_read_b128 v[116:119], v6 offset:6144
    ds_read_b128 v[120:123], v6 offset:7168
    ds_read_b128 v[124:127], v7 offset:4096
    ds_read_b128 v[128:131], v7 offset:5120
    ds_read_b128 v[132:135], v7 offset:6144
    ds_read_b128 v[136:139], v7 offset:7168
    ds_read_b128 v[140:143], v7 offset:36864
    ds_read_b128 v[144:147], v7 offset:37888
    ds_read_b128 v[148:151], v7 offset:38912
    ds_read_b128 v[152:155], v7 offset:39936
    s_waitcnt lgkmcnt(0)
    v_pk_add_f32 v[108:109], v[108:109], v[124:125]
    v_pk_add_f32 v[92:93], v[92:93], v[140:141]
    v_pk_add_f32 v[110:111], v[110:111], v[126:127]
    v_pk_add_f32 v[94:95], v[94:95], v[142:143]
    v_pk_add_f32 v[112:113], v[112:113], v[128:129]
    v_pk_add_f32 v[96:97], v[96:97], v[144:145]
    v_pk_add_f32 v[114:115], v[114:115], v[130:131]
    v_pk_add_f32 v[98:99], v[98:99], v[146:147]
    v_pk_add_f32 v[116:117], v[116:117], v[132:133]
    v_pk_add_f32 v[100:101], v[100:101], v[148:149]
    v_pk_add_f32 v[118:119], v[118:119], v[134:135]
    v_pk_add_f32 v[102:103], v[102:103], v[150:151]
    v_pk_add_f32 v[120:121], v[120:121], v[136:137]
    v_pk_add_f32 v[104:105], v[104:105], v[152:153]
    v_pk_add_f32 v[122:123], v[122:123], v[138:139]
    v_pk_add_f32 v[106:107], v[106:107], v[154:155]
    v_pk_add_f32 v[92:93], v[92:93], v[108:109]
    v_pk_add_f32 v[94:95], v[94:95], v[110:111]
    v_pk_add_f32 v[96:97], v[96:97], v[112:113]
    v_pk_add_f32 v[98:99], v[98:99], v[114:115]
    v_pk_add_f32 v[100:101], v[100:101], v[116:117]
    v_pk_add_f32 v[102:103], v[102:103], v[118:119]
    v_pk_add_f32 v[104:105], v[104:105], v[120:121]
    v_pk_add_f32 v[106:107], v[106:107], v[122:123]
    s_branch L_act
L_ep2:
    ds_write_b128 v5, a[0:3] offset:0
    ds_write_b128 v5, a[4:7] offset:1024
    ds_write_b128 v5, a[8:11] offset:2048
    ds_write_b128 v5, a[12:15] offset:3072
    ds_write_b128 v5, a[16:19] offset:4096
    ds_write_b128 v5, a[20:23] offset:5120
    ds_write_b128 v5, a[24:27] offset:6144
    ds_write_b128 v5, a[28:31] offset:7168
    ds_write_b128 v5, a[32:35] offset:8192
    ds_write_b128 v5, a[36:39] offset:9216
    ds_write_b128 v5, a[40:43] offset:10240
    ds_write_b128 v5, a[44:47] offset:11264
    ds_write_b128 v5, a[48:51] offset:12288
    ds_write_b128 v5, a[52:55] offset:13312
    ds_write_b128 v5, a[56:59] offset:14336
    ds_write_b128 v5, a[60:63] offset:15360
    ds_write_b128 v5, a[96:99] offset:24576
    ds_write_b128 v5, a[100:103] offset:25600
    ds_write_b128 v5, a[104:107] offset:26624
    ds_write_b128 v5, a[108:111] offset:27648
    ds_write_b128 v5, a[112:115] offset:28672
    ds_write_b128 v5, a[116:119] offset:29696
    ds_write_b128 v5, a[120:123] offset:30720
    ds_write_b128 v5, a[124:127] offset:31744
    v_accvgpr_read_b32 v76, a64
    v_accvgpr_read_b32 v77, a65
    v_accvgpr_read_b32 v78, a66
    v_accvgpr_read_b32 v79, a67
    v_accvgpr_read_b32 v80, a68
    v_accvgpr_read_b32 v81, a69
    v_accvgpr_read_b32 v82, a70
    v_accvgpr_read_b32 v83, a71
    v_accvgpr_read_b32 v84, a72
    v_accvgpr_read_b32 v85, a73
    v_accvgpr_read_b32 v86, a74
    v_accvgpr_read_b32 v87, a75
    v_accvgpr_read_b32 v88, a76
    v_accvgpr_read_b32 v89, a77
    v_accvgpr_read_b32 v90, a78
    v_accvgpr_read_b32 v91, a79
    v_accvgpr_read_b32 v92, a80
    v_accvgpr_read_b32 v93, a81
    v_accvgpr_read_b32 v94, a82
    v_accvgpr_read_b32 v95, a83
    v_accvgpr_read_b32 v96, a84
    v_accvgpr_read_b32 v97, a85
    v_accvgpr_read_b32 v98, a86
    v_accvgpr_read_b32 v99, a87
    v_accvgpr_read_b32 v100, a88
    v_accvgpr_read_b32 v101, a89
    v_accvgpr_read_b32 v102, a90
    v_accvgpr_read_b32 v103, a91
    v_accvgpr_read_b32 v104, a92
    v_accvgpr_read_b32 v105, a93
    v_accvgpr_read_b32 v106, a94
    v_accvgpr_read_b32 v107, a95
    s_waitcnt lgkmcnt(0)
    s_barrier
    ds_read_b128 v[108:111], v6 offset:0
    ds_read_b128 v[112:115], v6 offset:1024
    ds_read_b128 v[116:119], v6 offset:2048
    ds_read_b128 v[120:123], v6 offset:3072
    ds_read_b128 v[124:127], v6 offset:32768
    ds_read_b128 v[128:131], v6 offset:33792
    ds_read_b128 v[132:135], v6 offset:34816
    ds_read_b128 v[136:139], v6 offset:35840
    ds_read_b128 v[140:143], v7 offset:32768
    ds_read_b128 v[144:147], v7 offset:33792
    ds_read_b128 v[148:151], v7 offset:34816
    ds_read_b128 v[152:155], v7 offset:35840
    s_waitcnt lgkmcnt(0)
    v_pk_add_f32 v[108:109], v[108:109], v[124:125]
    v_pk_add_f32 v[76:77], v[76:77], v[140:141]
    v_pk_add_f32 v[110:111], v[110:111], v[126:127]
    v_pk_add_f32 v[78:79], v[78:79], v[142:143]
    v_pk_add_f32 v[112:113], v[112:113], v[128:129]
    v_pk_add_f32 v[80:81], v[80:81], v[144:145]
    v_pk_add_f32 v[114:115], v[114:115], v[130:131]
    v_pk_add_f32 v[82:83], v[82:83], v[146:147]
    v_pk_add_f32 v[116:117], v[116:117], v[132:133]
    v_pk_add_f32 v[84:85], v[84:85], v[148:149]
    v_pk_add_f32 v[118:119], v[118:119], v[134:135]
    v_pk_add_f32 v[86:87], v[86:87], v[150:151]
    v_pk_add_f32 v[120:121], v[120:121], v[136:137]
    v_pk_add_f32 v[88:89], v[88:89], v[152:153]
    v_pk_add_f32 v[122:123], v[122:123], v[138:139]
    v_pk_add_f32 v[90:91], v[90:91], v[154:155]
    v_pk_add_f32 v[76:77], v[76:77], v[108:109]
    v_pk_add_f32 v[78:79], v[78:79], v[110:111]
    v_pk_add_f32 v[80:81], v[80:81], v[112:113]
    v_pk_add_f32 v[82:83], v[82:83], v[114:115]
    v_pk_add_f32 v[84:85], v[84:85], v[116:117]
    v_pk_add_f32 v[86:87], v[86:87], v[118:119]
    v_pk_add_f32 v[88:89], v[88:89], v[120:121]
    v_pk_add_f32 v[90:91], v[90:91], v[122:123]
    ds_read_b128 v[108:111], v6 offset:4096
    ds_read_b128 v[112:115], v6 offset:5120
    ds_read_b128 v[116:119], v6 offset:6144
    ds_read_b128 v[120:123], v6 offset:7168
    ds_read_b128 v[124:127], v6 offset:36864
    ds_read_b128 v[128:131], v6 offset:37888
    ds_read_b128 v[132:135], v6 offset:38912
    ds_read_b128 v[136:139], v6 offset:39936
    ds_read_b128 v[140:143], v7 offset:36864
    ds_read_b128 v[144:147], v7 offset:37888
    ds_read_b128 v[148:151], v7 offset:38912
    ds_read_b128 v[152:155], v7 offset:39936
    s_waitcnt lgkmcnt(0)
    v_pk_add_f32 v[108:109], v[108:109], v[124:125]
    v_pk_add_f32 v[92:93], v[92:93], v[140:141]
    v_pk_add_f32 v[110:111], v[110:111], v[126:127]
    v_pk_add_f32 v[94:95], v[94:95], v[142:143]
    v_pk_add_f32 v[112:113], v[112:113], v[128:129]
    v_pk_add_f32 v[96:97], v[96:97], v[144:145]
    v_pk_add_f32 v[114:115], v[114:115], v[130:131]
    v_pk_add_f32 v[98:99], v[98:99], v[146:147]
    v_pk_add_f32 v[116:117], v[116:117], v[132:133]
    v_pk_add_f32 v[100:101], v[100:101], v[148:149]
    v_pk_add_f32 v[118:119], v[118:119], v[134:135]
    v_pk_add_f32 v[102:103], v[102:103], v[150:151]
    v_pk_add_f32 v[120:121], v[120:121], v[136:137]
    v_pk_add_f32 v[104:105], v[104:105], v[152:153]
    v_pk_add_f32 v[122:123], v[122:123], v[138:139]
    v_pk_add_f32 v[106:107], v[106:107], v[154:155]
    v_pk_add_f32 v[92:93], v[92:93], v[108:109]
    v_pk_add_f32 v[94:95], v[94:95], v[110:111]
    v_pk_add_f32 v[96:97], v[96:97], v[112:113]
    v_pk_add_f32 v[98:99], v[98:99], v[114:115]
    v_pk_add_f32 v[100:101], v[100:101], v[116:117]
    v_pk_add_f32 v[102:103], v[102:103], v[118:119]
    v_pk_add_f32 v[104:105], v[104:105], v[120:121]
    v_pk_add_f32 v[106:107], v[106:107], v[122:123]
    s_branch L_act
L_ep3:
    ds_write_b128 v5, a[0:3] offset:0
    ds_write_b128 v5, a[4:7] offset:1024
    ds_write_b128 v5, a[8:11] offset:2048
    ds_write_b128 v5, a[12:15] offset:3072
    ds_write_b128 v5, a[16:19] offset:4096
    ds_write_b128 v5, a[20:23] offset:5120
    ds_write_b128 v5, a[24:27] offset:6144
    ds_write_b128 v5, a[28:31] offset:7168
    ds_write_b128 v5, a[32:35] offset:8192
    ds_write_b128 v5, a[36:39] offset:9216
    ds_write_b128 v5, a[40:43] offset:10240
    ds_write_b128 v5, a[44:47] offset:11264
    ds_write_b128 v5, a[48:51] offset:12288
    ds_write_b128 v5, a[52:55] offset:13312
    ds_write_b128 v5, a[56:59] offset:14336
    ds_write_b128 v5, a[60:63] offset:15360
    ds_write_b128 v5, a[64:67] offset:16384
    ds_write_b128 v5, a[68:71] offset:17408
    ds_write_b128 v5, a[72:75] offset:18432
    ds_write_b128 v5, a[76:79] offset:19456
    ds_write_b128 v5, a[80:83] offset:20480
    ds_write_b128 v5, a[84:87] offset:21504
    ds_write_b128 v5, a[88:91] offset:22528
    ds_write_b128 v5, a[92:95] offset:23552
    v_accvgpr_read_b32 v76, a96
    v_accvgpr_read_b32 v77, a97
    v_accvgpr_read_b32 v78, a98
    v_accvgpr_read_b32 v79, a99
    v_accvgpr_read_b32 v80, a100
    v_accvgpr_read_b32 v81, a101
    v_accvgpr_read_b32 v82, a102
    v_accvgpr_read_b32 v83, a103
    v_accvgpr_read_b32 v84, a104
    v_accvgpr_read_b32 v85, a105
    v_accvgpr_read_b32 v86, a106
    v_accvgpr_read_b32 v87, a107
    v_accvgpr_read_b32 v88, a108
    v_accvgpr_read_b32 v89, a109
    v_accvgpr_read_b32 v90, a110
    v_accvgpr_read_b32 v91, a111
    v_accvgpr_read_b32 v92, a112
    v_accvgpr_read_b32 v93, a113
    v_accvgpr_read_b32 v94, a114
    v_accvgpr_read_b32 v95, a115
    v_accvgpr_read_b32 v96, a116
    v_accvgpr_read_b32 v97, a117
    v_accvgpr_read_b32 v98, a118
    v_accvgpr_read_b32 v99, a119
    v_accvgpr_read_b32 v100, a120
    v_accvgpr_read_b32 v101, a121
    v_accvgpr_read_b32 v102, a122
    v_accvgpr_read_b32 v103, a123
    v_accvgpr_read_b32 v104, a124
    v_accvgpr_read_b32 v105, a125
    v_accvgpr_read_b32 v106, a126
    v_accvgpr_read_b32 v107, a127
    s_waitcnt lgkmcnt(0)
    s_barrier
    ds_read_b128 v[108:111], v6 offset:0
    ds_read_b128 v[112:115], v6 offset:1024
    ds_read_b128 v[116:119], v6 offset:2048
    ds_read_b128 v[120:123], v6 offset:3072
    ds_read_b128 v[124:127], v6 offset:32768
    ds_read_b128 v[128:131], v6 offset:33792
    ds_read_b128 v[132:135], v6 offset:34816
    ds_read_b128 v[136:139], v6 offset:35840
    ds_read_b128 v[140:143], v7 offset:0
    ds_read_b128 v[144:147], v7 offset:1024
    ds_read_b128 v[148:151], v7 offset:2048
    ds_read_b128 v[152:155], v7 offset:3072
    s_waitcnt lgkmcnt(0)
    v_pk_add_f32 v[108:109], v[108:109], v[124:125]
    v_pk_add_f32 v[76:77], v[76:77], v[140:141]
    v_pk_add_f32 v[110:111], v[110:111], v[126:127]
    v_pk_add_f32 v[78:79], v[78:79], v[142:143]
    v_pk_add_f32 v[112:113], v[112:113], v[128:129]
    v_pk_add_f32 v[80:81], v[80:81], v[144:145]
    v_pk_add_f32 v[114:115], v[114:115], v[130:131]
    v_pk_add_f32 v[82:83], v[82:83], v[146:147]
    v_pk_add_f32 v[116:117], v[116:117], v[132:133]
    v_pk_add_f32 v[84:85], v[84:85], v[148:149]
    v_pk_add_f32 v[118:119], v[118:119], v[134:135]
    v_pk_add_f32 v[86:87], v[86:87], v[150:151]
    v_pk_add_f32 v[120:121], v[120:121], v[136:137]
    v_pk_add_f32 v[88:89], v[88:89], v[152:153]
    v_pk_add_f32 v[122:123], v[122:123], v[138:139]
    v_pk_add_f32 v[90:91], v[90:91], v[154:155]
    v_pk_add_f32 v[76:77], v[76:77], v[108:109]
    v_pk_add_f32 v[78:79], v[78:79], v[110:111]
    v_pk_add_f32 v[80:81], v[80:81], v[112:113]
    v_pk_add_f32 v[82:83], v[82:83], v[114:115]
    v_pk_add_f32 v[84:85], v[84:85], v[116:117]
    v_pk_add_f32 v[86:87], v[86:87], v[118:119]
    v_pk_add_f32 v[88:89], v[88:89], v[120:121]
    v_pk_add_f32 v[90:91], v[90:91], v[122:123]
    ds_read_b128 v[108:111], v6 offset:4096
    ds_read_b128 v[112:115], v6 offset:5120
    ds_read_b128 v[116:119], v6 offset:6144
    ds_read_b128 v[120:123], v6 offset:7168
    ds_read_b128 v[124:127], v6 offset:36864
    ds_read_b128 v[128:131], v6 offset:37888
    ds_read_b128 v[132:135], v6 offset:38912
    ds_read_b128 v[136:139], v6 offset:39936
    ds_read_b128 v[140:143], v7 offset:4096
    ds_read_b128 v[144:147], v7 offset:5120
    ds_read_b128 v[148:151], v7 offset:6144
    ds_read_b128 v[152:155], v7 offset:7168
    s_waitcnt lgkmcnt(0)
    v_pk_add_f32 v[108:109], v[108:109], v[124:125]
    v_pk_add_f32 v[92:93], v[92:93], v[140:141]
    v_pk_add_f32 v[110:111], v[110:111], v[126:127]
    v_pk_add_f32 v[94:95], v[94:95], v[142:143]
    v_pk_add_f32 v[112:113], v[112:113], v[128:129]
    v_pk_add_f32 v[96:97], v[96:97], v[144:145]
    v_pk_add_f32 v[114:115], v[114:115], v[130:131]
    v_pk_add_f32 v[98:99], v[98:99], v[146:147]
    v_pk_add_f32 v[116:117], v[116:117], v[132:133]
    v_pk_add_f32 v[100:101], v[100:101], v[148:149]
    v_pk_add_f32 v[118:119], v[118:119], v[134:135]
    v_pk_add_f32 v[102:103], v[102:103], v[150:151]
    v_pk_add_f32 v[120:121], v[120:121], v[136:137]
    v_pk_add_f32 v[104:105], v[104:105], v[152:153]
    v_pk_add_f32 v[122:123], v[122:123], v[138:139]
    v_pk_add_f32 v[106:107], v[106:107], v[154:155]
    v_pk_add_f32 v[92:93], v[92:93], v[108:109]
    v_pk_add_f32 v[94:95], v[94:95], v[110:111]
    v_pk_add_f32 v[96:97], v[96:97], v[112:113]
    v_pk_add_f32 v[98:99], v[98:99], v[114:115]
    v_pk_add_f32 v[100:101], v[100:101], v[116:117]
    v_pk_add_f32 v[102:103], v[102:103], v[118:119]
    v_pk_add_f32 v[104:105], v[104:105], v[120:121]
    v_pk_add_f32 v[106:107], v[106:107], v[122:123]
L_act:
    s_mov_b32 s52, 0x4038aa3b
    s_mov_b32 s53, 0xbfb8aa3b
    s_mov_b32 s55, 0x42700000
    s_lshl_b32 s30, s24, 5
    s_add_u32 s30, s30, s28
    v_lshl_add_u32 v8, v4, 2, s30
    v_lshlrev_b32 v8, 10, v8
    v_add_u32 v9, s29, v3
    v_lshl_add_u32 v8, v9, 1, v8
    v_mul_f32 v108, s52, v76
    v_mul_f32 v109, s53, v92
    v_min_f32 v108, s55, v108
    v_min_f32 v109, s55, v109
    v_exp_f32 v108, v108
    v_exp_f32 v109, v109
    v_mul_f32 v116, s52, v77
    v_mul_f32 v117, s53, v93
    v_min_f32 v116, s55, v116
    v_min_f32 v117, s55, v117
    v_exp_f32 v116, v116
    v_exp_f32 v117, v117
    v_add_f32 v110, 1.0, v108
    v_add_f32 v111, -1.0, v108
    v_fma_f32 v110, v110, v109, v110
    v_rcp_f32 v110, v110
    v_add_f32 v118, 1.0, v116
    v_add_f32 v119, -1.0, v116
    v_fma_f32 v118, v118, v117, v118
    v_rcp_f32 v118, v118
    v_mul_f32 v76, v111, v110
    v_mul_f32 v77, v119, v118
    v_cvt_pk_bf16_f32 v76, v76, v77
    s_mov_b32 s31, 0
    buffer_store_short v76, v8, s[20:23], s31 offen
    s_mov_b32 s31, 1024
    buffer_store_short_d16_hi v76, v8, s[20:23], s31 offen
    v_mul_f32 v108, s52, v78
    v_mul_f32 v109, s53, v94
    v_min_f32 v108, s55, v108
    v_min_f32 v109, s55, v109
    v_exp_f32 v108, v108
    v_exp_f32 v109, v109
    v_mul_f32 v116, s52, v79
    v_mul_f32 v117, s53, v95
    v_min_f32 v116, s55, v116
    v_min_f32 v117, s55, v117
    v_exp_f32 v116, v116
    v_exp_f32 v117, v117
    v_add_f32 v110, 1.0, v108
    v_add_f32 v111, -1.0, v108
    v_fma_f32 v110, v110, v109, v110
    v_rcp_f32 v110, v110
    v_add_f32 v118, 1.0, v116
    v_add_f32 v119, -1.0, v116
    v_fma_f32 v118, v118, v117, v118
    v_rcp_f32 v118, v118
    v_mul_f32 v78, v111, v110
    v_mul_f32 v79, v119, v118
    v_cvt_pk_bf16_f32 v78, v78, v79
    s_mov_b32 s31, 2048
    buffer_store_short v78, v8, s[20:23], s31 offen
    s_mov_b32 s31, 3072
    buffer_store_short_d16_hi v78, v8, s[20:23], s31 offen
    v_mul_f32 v108, s52, v80
    v_mul_f32 v109, s53, v96
    v_min_f32 v108, s55, v108
    v_min_f32 v109, s55, v109
    v_exp_f32 v108, v108
    v_exp_f32 v109, v109
    v_mul_f32 v116, s52, v81
    v_mul_f32 v117, s53, v97
    v_min_f32 v116, s55, v116
    v_min_f32 v117, s55, v117
    v_exp_f32 v116, v116
    v_exp_f32 v117, v117
    v_add_f32 v110, 1.0, v108
    v_add_f32 v111, -1.0, v108
    v_fma_f32 v110, v110, v109, v110
    v_rcp_f32 v110, v110
    v_add_f32 v118, 1.0, v116
    v_add_f32 v119, -1.0, v116
    v_fma_f32 v118, v118, v117, v118
    v_rcp_f32 v118, v118
    v_mul_f32 v80, v111, v110
    v_mul_f32 v81, v119, v118
    v_cvt_pk_bf16_f32 v80, v80, v81
    s_mov_b32 s31, 8192
    buffer_store_short v80, v8, s[20:23], s31 offen
    s_mov_b32 s31, 9216
    buffer_store_short_d16_hi v80, v8, s[20:23], s31 offen
    v_mul_f32 v108, s52, v82
    v_mul_f32 v109, s53, v98
    v_min_f32 v108, s55, v108
    v_min_f32 v109, s55, v109
    v_exp_f32 v108, v108
    v_exp_f32 v109, v109
    v_mul_f32 v116, s52, v83
    v_mul_f32 v117, s53, v99
    v_min_f32 v116, s55, v116
    v_min_f32 v117, s55, v117
    v_exp_f32 v116, v116
    v_exp_f32 v117, v117
    v_add_f32 v110, 1.0, v108
    v_add_f32 v111, -1.0, v108
    v_fma_f32 v110, v110, v109, v110
    v_rcp_f32 v110, v110
    v_add_f32 v118, 1.0, v116
    v_add_f32 v119, -1.0, v116
    v_fma_f32 v118, v118, v117, v118
    v_rcp_f32 v118, v118
    v_mul_f32 v82, v111, v110
    v_mul_f32 v83, v119, v118
    v_cvt_pk_bf16_f32 v82, v82, v83
    s_mov_b32 s31, 10240
    buffer_store_short v82, v8, s[20:23], s31 offen
    s_mov_b32 s31, 11264
    buffer_store_short_d16_hi v82, v8, s[20:23], s31 offen
    v_mul_f32 v108, s52, v84
    v_mul_f32 v109, s53, v100
    v_min_f32 v108, s55, v108
    v_min_f32 v109, s55, v109
    v_exp_f32 v108, v108
    v_exp_f32 v109, v109
    v_mul_f32 v116, s52, v85
    v_mul_f32 v117, s53, v101
    v_min_f32 v116, s55, v116
    v_min_f32 v117, s55, v117
    v_exp_f32 v116, v116
    v_exp_f32 v117, v117
    v_add_f32 v110, 1.0, v108
    v_add_f32 v111, -1.0, v108
    v_fma_f32 v110, v110, v109, v110
    v_rcp_f32 v110, v110
    v_add_f32 v118, 1.0, v116
    v_add_f32 v119, -1.0, v116
    v_fma_f32 v118, v118, v117, v118
    v_rcp_f32 v118, v118
    v_mul_f32 v84, v111, v110
    v_mul_f32 v85, v119, v118
    v_cvt_pk_bf16_f32 v84, v84, v85
    s_mov_b32 s31, 16384
    buffer_store_short v84, v8, s[20:23], s31 offen
    s_mov_b32 s31, 17408
    buffer_store_short_d16_hi v84, v8, s[20:23], s31 offen
    v_mul_f32 v108, s52, v86
    v_mul_f32 v109, s53, v102
    v_min_f32 v108, s55, v108
    v_min_f32 v109, s55, v109
    v_exp_f32 v108, v108
    v_exp_f32 v109, v109
    v_mul_f32 v116, s52, v87
    v_mul_f32 v117, s53, v103
    v_min_f32 v116, s55, v116
    v_min_f32 v117, s55, v117
    v_exp_f32 v116, v116
    v_exp_f32 v117, v117
    v_add_f32 v110, 1.0, v108
    v_add_f32 v111, -1.0, v108
    v_fma_f32 v110, v110, v109, v110
    v_rcp_f32 v110, v110
    v_add_f32 v118, 1.0, v116
    v_add_f32 v119, -1.0, v116
    v_fma_f32 v118, v118, v117, v118
    v_rcp_f32 v118, v118
    v_mul_f32 v86, v111, v110
    v_mul_f32 v87, v119, v118
    v_cvt_pk_bf16_f32 v86, v86, v87
    s_mov_b32 s31, 18432
    buffer_store_short v86, v8, s[20:23], s31 offen
    s_mov_b32 s31, 19456
    buffer_store_short_d16_hi v86, v8, s[20:23], s31 offen
    v_mul_f32 v108, s52, v88
    v_mul_f32 v109, s53, v104
    v_min_f32 v108, s55, v108
    v_min_f32 v109, s55, v109
    v_exp_f32 v108, v108
    v_exp_f32 v109, v109
    v_mul_f32 v116, s52, v89
    v_mul_f32 v117, s53, v105
    v_min_f32 v116, s55, v116
    v_min_f32 v117, s55, v117
    v_exp_f32 v116, v116
    v_exp_f32 v117, v117
    v_add_f32 v110, 1.0, v108
    v_add_f32 v111, -1.0, v108
    v_fma_f32 v110, v110, v109, v110
    v_rcp_f32 v110, v110
    v_add_f32 v118, 1.0, v116
    v_add_f32 v119, -1.0, v116
    v_fma_f32 v118, v118, v117, v118
    v_rcp_f32 v118, v118
    v_mul_f32 v88, v111, v110
    v_mul_f32 v89, v119, v118
    v_cvt_pk_bf16_f32 v88, v88, v89
    s_mov_b32 s31, 24576
    buffer_store_short v88, v8, s[20:23], s31 offen
    s_mov_b32 s31, 25600
    buffer_store_short_d16_hi v88, v8, s[20:23], s31 offen
    v_mul_f32 v108, s52, v90
    v_mul_f32 v109, s53, v106
    v_min_f32 v108, s55, v108
    v_min_f32 v109, s55, v109
    v_exp_f32 v108, v108
    v_exp_f32 v109, v109
    v_mul_f32 v116, s52, v91
    v_mul_f32 v117, s53, v107
    v_min_f32 v116, s55, v116
    v_min_f32 v117, s55, v117
    v_exp_f32 v116, v116
    v_exp_f32 v117, v117
    v_add_f32 v110, 1.0, v108
    v_add_f32 v111, -1.0, v108
    v_fma_f32 v110, v110, v109, v110
    v_rcp_f32 v110, v110
    v_add_f32 v118, 1.0, v116
    v_add_f32 v119, -1.0, v116
    v_fma_f32 v118, v118, v117, v118
    v_rcp_f32 v118, v118
    v_mul_f32 v90, v111, v110
    v_mul_f32 v91, v119, v118
    v_cvt_pk_bf16_f32 v90, v90, v91
    s_mov_b32 s31, 26624
    buffer_store_short v90, v8, s[20:23], s31 offen
    s_mov_b32 s31, 27648
    buffer_store_short_d16_hi v90, v8, s[20:23], s31 offen
L_done:
    s_endpgm
.section .rodata,"a"
.p2align 6
.amdhsa_kernel standalone__autoregressive_conv_wavernn__speech_kernel
  .amdhsa_next_free_vgpr 288
  .amdhsa_next_free_sgpr 96
  .amdhsa_accum_offset 160
  .amdhsa_group_segment_fixed_size 0
  .amdhsa_kernarg_size 40
  .amdhsa_user_sgpr_count 2
  .amdhsa_user_sgpr_kernarg_segment_ptr 1
  .amdhsa_system_sgpr_workgroup_id_x 1
.end_amdhsa_kernel
```
